```python
import torch

def _softmax(x, axis=-1):
    return torch.softmax(x, dim=axis)
def _gelu(x):
    return torch.nn.functional.gelu(x, approximate="tanh")
def _silu(x):
    return torch.nn.functional.silu(x)
def _sigmoid(x):
    return torch.sigmoid(x)
def _layernorm(x, axis=-1, eps=1e-5):
    m = x.mean(dim=axis, keepdim=True)
    v = x.var(dim=axis, keepdim=True, unbiased=False)
    return (x - m) / torch.sqrt(v + eps)
def _scatter_add(tgt, idx, src, axis=0):
    return tgt.clone().index_add_(axis, idx, src)
def _segment_sum(src, seg, n):
    out = torch.zeros((n,) + src.shape[1:], dtype=src.dtype)
    return out.index_add_(0, seg, src)
def _pad(x, pw):
    flat = tuple(v for pair in reversed(pw) for v in pair)
    return torch.nn.functional.pad(x, flat)

kernel_name = 'recurrent_scan__sliding_local_dilated__swiglu_ffn__prompt'

def setup_inputs():

    _w = (lambda a: (lambda t: t.to(torch.bfloat16) if t.is_floating_point() else t)(torch.as_tensor(a)))
    def _A_setup():
        B, S, D = 1, 2048, 512
        return {
            "x": _w((lambda *s: torch.randn(*s, dtype=torch.bfloat16) * 0.05)(B, S, D)),
            "wqkv": _w((lambda *s: torch.randn(*s, dtype=torch.bfloat16) * 0.05)(D, 3 * D)),
            "wo": _w((lambda *s: torch.randn(*s, dtype=torch.bfloat16) * 0.05)(D, D)),
        }
    _A_in = _A_setup()

    def _B_setup():
        B, S, D, F = 1, 2048, 512, 1376
        return {
            "x": _w((lambda *s: torch.randn(*s, dtype=torch.bfloat16) * 0.05)(B, S, D)),
            "w_gate": _w((lambda *s: torch.randn(*s, dtype=torch.bfloat16) * 0.05)(D, F)),
            "w_up": _w((lambda *s: torch.randn(*s, dtype=torch.bfloat16) * 0.05)(D, F)),
            "w_down": _w((lambda *s: torch.randn(*s, dtype=torch.bfloat16) * 0.05)(F, D)),
        }
    _B_in = _B_setup()

    return {
        "A_x": _A_in["x"],
        "A_wqkv": _A_in["wqkv"],
        "A_wo": _A_in["wo"],
        "B_x": _B_in["x"],
        "B_w_gate": _B_in["w_gate"],
        "B_w_up": _B_in["w_up"],
        "B_w_down": _B_in["w_down"],
    }

def reference(A_x, A_wqkv, A_wo, B_x, B_w_gate, B_w_up, B_w_down):
    def _A_ref(x, wqkv, wo):
        B, S, D = x.shape
        H = 32; Dh = D // H
        W, dil = 8, 2
        qkv = (lambda x, *d: x.permute(*d))((x @ wqkv).reshape(B, S, 3, H, Dh), 2, 0, 3, 1, 4)
        q, k, v = qkv[0], qkv[1], qkv[2]
        scale = Dh ** -0.5
        pos = torch.arange(S)
        off = torch.arange(W) * dil
        idx = pos[:, None] - off[None, :]
        mask = idx >= 0
        idx_c = torch.where(mask, idx, 0).reshape(-1)
        kg = k[:, :, idx_c, :].reshape(B, H, S, W, Dh)
        vg = v[:, :, idx_c, :].reshape(B, H, S, W, Dh)
        logits = torch.einsum("bhsd,bhswd->bhsw", q, kg) * scale
        logits = torch.where(mask[None, None, :, :], logits, -1e9)
        attn = _softmax(logits, axis=-1)
        o = torch.einsum("bhsw,bhswd->bhsd", attn, vg)
        return (lambda x, *d: x.permute(*d))(o, 0, 2, 1, 3).reshape(B, S, D) @ wo

    def _B_ref(x, w_gate, w_up, w_down):
        g = _silu(x @ w_gate)
        u = x @ w_up
        return (g * u) @ w_down

    x = A_x
    xn = _layernorm(x, axis=-1)
    s = _A_ref(xn, A_wqkv, A_wo)
    g = _silu(_B_ref(xn, B_w_gate, B_w_up, B_w_down))
    return x + s * g
```

```asm
; @launch grid=(256,1,1) block=(512,1,1) lds=163840
.amdgcn_target "amdgcn-amd-amdhsa--gfx950"
.text
.globl recurrent_scan__sliding_local_dilated__swiglu_ffn__prompt_kernel
.p2align 8
.type recurrent_scan__sliding_local_dilated__swiglu_ffn__prompt_kernel,@function
recurrent_scan__sliding_local_dilated__swiglu_ffn__prompt_kernel:
    s_load_dwordx16 s[32:47], s[0:1], 0
    s_load_dwordx4 s[28:31], s[0:1], 64
    s_cmp_ge_u32 s2, 256
    s_cbranch_scc1 L_end
    s_getpc_b64 s[78:79]
    v_lshlrev_b32 v1, 6, v0
    global_load_dword v19, v1, s[78:79]
    v_lshrrev_b32 v1, 6, v0
    v_and_b32 v0, 63, v0
    v_readfirstlane_b32 s3, v1
    s_and_b32 s69, s2, 7
    s_lshr_b32 s70, s2, 3
    s_lshr_b32 s71, s69, 1
    s_and_b32 s72, s69, 1
    s_mov_b32 s62, 0x3f803f80
    v_lshrrev_b32 v30, 3, v0
    v_and_b32 v31, 7, v0
    v_lshrrev_b32 v32, 4, v0
    v_lshlrev_b32 v29, 4, v0
    v_xor_b32 v1, v31, v32
    v_lshlrev_b32 v1, 4, v1
    v_lshl_add_u32 v4, v30, 11, v1
    s_mov_b32 s60, 0
    s_cmp_ge_u32 s70, 20
    s_cbranch_scc1 L_attn
    s_mul_i32 s66, s70, 52
    s_lshr_b32 s66, s66, 8
    s_mul_i32 s67, s66, 5
    s_sub_u32 s67, s70, s67
    s_cmp_lt_u32 s67, 3
    s_cselect_b32 s78, 3, 2
    s_cselect_b32 s79, 0, 3
    s_mul_i32 s72, s72, s78
    s_add_u32 s67, s67, s72
    s_add_u32 s67, s67, s79
    s_lshl_b32 s71, s71, 2
    s_add_u32 s66, s66, s71
    v_xor_b32 v5, 64, v4
    v_add_u32 v5, 15360, v5
    s_lshr_b32 s69, s3, 2
    s_and_b32 s70, s3, 1
    s_add_u32 s71, s69, 4
    s_mul_i32 s71, s71, s70
    s_lshl_b32 s72, s69, 3
    s_add_u32 s71, s71, s72
    s_lshl_b32 s72, s71, 6
    v_add_u32 v1, s72, v0
    s_movk_i32 s78, 3641
    s_movk_i32 s79, 2464
    v_mul_u32_u24 v2, s78, v1
    v_lshrrev_b32 v2, 16, v2
    v_mul_u32_u24 v2, s79, v2
    v_lshl_add_u32 v6, v1, 4, v2
    v_add_u32 v1, 64, v1
    v_mul_u32_u24 v2, s78, v1
    v_lshrrev_b32 v2, 16, v2
    v_mul_u32_u24 v2, s79, v2
    v_lshl_add_u32 v7, v1, 4, v2
    v_subrev_u32 v7, 1024, v7
    v_add_u32 v1, 64, v1
    v_mul_u32_u24 v2, s78, v1
    v_lshrrev_b32 v2, 16, v2
    v_mul_u32_u24 v2, s79, v2
    v_lshl_add_u32 v8, v1, 4, v2
    v_subrev_u32 v8, 2048, v8
    v_add_u32 v1, 64, v1
    v_mul_u32_u24 v2, s78, v1
    v_lshrrev_b32 v2, 16, v2
    v_mul_u32_u24 v2, s79, v2
    v_lshl_add_u32 v9, v1, 4, v2
    v_subrev_u32 v9, 3072, v9
    v_add_u32 v1, 64, v1
    v_mul_u32_u24 v2, s78, v1
    v_lshrrev_b32 v2, 16, v2
    v_mul_u32_u24 v2, s79, v2
    v_lshl_add_u32 v10, v1, 4, v2
    s_bfe_u32 s72, s3, 0x10001
    s_mul_i32 s57, s72, 18560
    s_lshl_b32 s71, s71, 10
    s_add_u32 s57, s57, s71
    s_add_u32 s57, s57, 16384
    s_lshl_b32 s56, s3, 11
    s_mul_i32 s74, s67, 9
    s_sub_u32 s71, s67, 6
    s_max_i32 s71, s71, 0
    s_sub_u32 s74, s74, s71
    s_lshl_b32 s51, s74, 5
    s_lshl_b32 s50, s66, 7
    s_lshl_b32 s71, s69, 6
    s_add_u32 s50, s50, s71
    s_add_u32 s50, s50, s72
    s_lshl_b32 s71, s70, 5
    s_add_u32 s50, s50, s71
    s_lshl_b32 s50, s50, 10
    s_mov_b32 s53, 176128
    s_lshr_b32 s49, s66, 1
    s_cmp_lt_u32 s67, 6
    s_cselect_b32 s59, 5, 4
    s_lshl_b32 s54, s49, 7
    s_add_u32 s54, s54, s50
    s_mul_i32 s55, s49, s53
    s_add_u32 s55, s55, s51
    s_add_u32 s49, s49, 1
    s_and_b32 s49, s49, 7
    s_cmp_eq_u32 s72, 1
    s_waitcnt lgkmcnt(0)
    s_cselect_b32 s8, s42, s40
    s_cselect_b32 s9, s43, s41
    s_mov_b32 s10, 1409024
    s_mov_b32 s11, 0x20000
    s_mov_b32 s20, s32
    s_mov_b32 s21, s33
    s_mov_b32 s22, 2097152
    s_mov_b32 s23, 0x20000
    s_lshl_b32 s69, s2, 13
    s_lshl_b32 s70, s3, 10
    s_add_u32 s69, s69, s70
    buffer_load_dwordx4 v[48:51], v29, s[20:23], s69 offen
    s_mov_b32 s4, s32
    s_mov_b32 s5, s33
    s_mov_b32 s6, 2097152
    s_mov_b32 s7, 0x20000
    s_add_u32 m0, s60, s57
    s_nop 0
    buffer_load_dwordx4 v6, s[8:11], s55 offen lds
    buffer_load_dwordx4 v7, s[8:11], s55 offen offset:1024 lds
    buffer_load_dwordx4 v8, s[8:11], s55 offen offset:2048 lds
    buffer_load_dwordx4 v9, s[8:11], s55 offen offset:3072 lds
    s_cmp_lt_u32 s3, 4
    s_cbranch_scc1 L_no51
    s_add_u32 m0, m0, 4096
    s_nop 0
    buffer_load_dwordx4 v10, s[8:11], s55 offen lds
L_no51:
    s_add_u32 m0, s60, s56
    s_nop 0
    buffer_load_dwordx4 v4, s[4:7], s54 offen lds
    buffer_load_dwordx4 v5, s[4:7], s54 offen offset:1024 lds
    s_or_b32 s69, s2, s3
    s_cmp_lg_u32 s69, 0
    s_cbranch_scc1 L_notag2
    s_memrealtime s[78:79]
    s_waitcnt lgkmcnt(0)
    s_or_b32 s78, s78, 1
    v_mov_b32 v1, 0
    v_mov_b32 v2, s78
    s_mov_b64 exec, 1
    global_store_dword v1, v2, s[28:29] sc1
    s_mov_b64 exec, -1
L_notag2:
    s_add_u32 s60, s60, 53504
    s_cmp_eq_u32 s60, 160512
    s_cselect_b32 s60, 0, s60
    s_lshl_b32 s54, s49, 7
    s_add_u32 s54, s54, s50
    s_mul_i32 s55, s49, s53
    s_add_u32 s55, s55, s51
    s_add_u32 s49, s49, 1
    s_and_b32 s49, s49, 7
    s_lshr_b32 s70, s2, 3
    s_mov_b32 s78, 1219594272
    s_mov_b32 s79, 77820721
    s_cmp_ge_u32 s70, 12
    s_cmov_b32 s78, 3705027818
    s_cmov_b32 s79, 172634365
    s_cselect_b32 s71, 12, 0
    s_cmp_ge_u32 s70, 24
    s_cmov_b32 s78, 2041373397
    s_cmov_b32 s79, 247
    s_cmov_b32 s71, 24
    s_sub_u32 s70, s70, s71
    s_mul_i32 s70, s70, 5
    s_lshr_b64 s[78:79], s[78:79], s70
    s_and_b32 s65, s78, 7
    s_bfe_u32 s64, s78, 0x20003
    s_and_b32 s70, s2, 7
    s_lshl_b32 s70, s70, 2
    s_add_u32 s64, s64, s70
    s_mov_b32 s80, s30
    s_mov_b32 s81, s31
    s_mov_b32 s82, 124928
    s_mov_b32 s83, 0x20000
    s_mov_b32 s24, s46
    s_mov_b32 s25, s47
    s_mov_b32 s26, 2097152
    s_mov_b32 s27, 0x20000
    s_add_u32 s12, s30, 1048576
    s_addc_u32 s13, s31, 0
    s_mov_b32 s14, 7733248
    s_mov_b32 s15, 0x20000
    s_lshr_b32 s52, s3, 1
    s_lshr_b32 s69, s3, 2
    s_xor_b32 s52, s52, s69
    s_and_b32 s73, s3, 1
    s_cmp_eq_u32 s52, 0
    s_cselect_b32 s16, s36, s44
    s_cselect_b32 s17, s37, s45
    s_mov_b32 s18, 1409024
    s_cmov_b32 s18, 524288
    s_mov_b32 s19, 0x20000
    s_mov_b32 s48, 0
    s_cmp_eq_u32 s3, 0
    s_cselect_b32 s0, 2, 0
    s_lshr_b32 s69, s3, 2
    s_add_u32 s69, s69, 3
    s_bitset1_b32 s0, s69
    v_lshrrev_b32 v1, 3, v0
    v_and_b32 v2, 7, v0
    v_bfe_u32 v3, v0, 4, 1
    v_lshlrev_b32 v3, 2, v3
    v_xor_b32 v2, v2, v3
    v_lshlrev_b32 v2, 4, v2
    v_lshl_add_u32 v25, v1, 10, v2
    v_add_u32 v26, 7168, v25
    v_add_u32 v27, 14336, v25
    v_add_u32 v28, 21504, v25
    s_sub_u32 s69, s52, 1
    s_max_i32 s69, s69, 0
    s_mul_i32 s76, s69, 475136
    s_lshl_b32 s69, s65, 7
    s_add_u32 s76, s76, s69
    v_mov_b32 v56, 0
    v_mov_b32 v57, 0
    v_mov_b32 v58, 0
    v_mov_b32 v59, 0
    s_nop 1
    v_mfma_f32_32x32x16_bf16 v[80:95], v[56:59], v[56:59], 0
    v_mfma_f32_32x32x16_bf16 v[96:111], v[56:59], v[56:59], 0
    v_mfma_f32_32x32x16_bf16 v[112:127], v[56:59], v[56:59], 0
    v_mfma_f32_32x32x16_bf16 v[128:143], v[56:59], v[56:59], 0
    v_mfma_f32_32x32x16_bf16 v[144:159], v[56:59], v[56:59], 0
    v_and_b32 v1, 31, v0
    s_and_b32 s69, s3, 3
    s_lshl_b32 s69, s69, 5
    v_add_u32 v1, s69, v1
    v_bfe_u32 v2, v1, 1, 3
    v_lshrrev_b32 v3, 5, v0
    v_xor_b32 v2, v2, v3
    v_lshlrev_b32 v2, 4, v2
    v_lshl_add_u32 v11, v1, 7, v2
    v_xor_b32 v12, 32, v11
    v_xor_b32 v13, 64, v11
    v_xor_b32 v14, 96, v11
    v_bfe_u32 v1, v0, 2, 2
    v_and_b32 v2, 3, v0
    v_lshlrev_b32 v2, 3, v2
    s_movk_i32 s69, 288
    v_mad_u32_u24 v35, v1, s69, v2
    v_mul_u32_u24 v2, 2304, v3
    v_bfe_u32 v1, v0, 4, 1
    v_mul_u32_u24 v15, 18560, v1
    v_add3_u32 v15, v15, v2, v35
    s_lshr_b32 s69, s3, 2
    s_mul_i32 s69, s69, s59
    s_lshl_b32 s69, s69, 5
    s_add_u32 s69, s69, 16384
    v_add_u32 v15, s69, v15
    s_and_b32 s69, s3, 1
    s_mul_i32 s69, s69, 18560
    s_add_u32 s69, s69, 16384
    v_add_u32 v35, s69, v35
    v_mul_u32_u24 v34, 1152, v32
    v_add_u32 v34, v34, v35
    v_mul_u32_u24 v33, 1152, v3
    v_lshl_add_u32 v33, v1, 7, v33
    s_lshr_b32 s70, s3, 1
    s_lshl_b32 s71, s70, 5
    v_add3_u32 v33, v33, v35, s71
    s_lshl_b32 s69, s2, 2
    s_add_u32 s69, s69, 11264
    s_lshl_b32 s72, s67, 5
    s_add_u32 s72, s72, 12288
    s_lshl_b32 s71, s66, 1
    s_add_u32 s78, s71, s72
    s_bitcmp0_b32 s66, 0
    s_cselect_b32 s78, s78, s69
    v_mov_b32 v23, s78
    v_writelane_b32 v23, s69, 0
    s_lshl_b32 s69, s66, 6
    s_add_u32 s69, s69, 11264
    v_and_b32 v2, 15, v0
    v_lshl_add_u32 v3, v2, 2, s69
    v_lshl_add_u32 v31, v31, 2, s72
    v_cmp_gt_u32 vcc, 32, v0
    s_nop 1
    v_cndmask_b32 v22, v31, v3, vcc
    s_mul_i32 s69, s67, 9216
    s_add_u32 s69, s69, s71
    s_and_b32 s72, s3, 1
    s_lshl_b32 s72, s72, 9
    s_add_u32 s69, s69, s72
    s_add_u32 s69, s69, 32768
    v_lshl_add_u32 v2, v2, 5, s69
    s_lshl_b32 s72, s70, 10
    v_lshlrev_b32 v35, 12, v1
    v_add3_u32 v35, v35, v2, s72
    v_mov_b32 v3, 2147483648
    v_cndmask_b32 v35, v3, v35, vcc
    v_add_u32 v32, 8192, v2
    s_cmp_eq_u32 s70, 0
    s_cselect_b32 s72, 16, 0
    v_cmp_gt_u32 vcc, s72, v0
    s_nop 1
    v_cndmask_b32 v32, v3, v32, vcc
    v_and_b32 v1, 31, v0
    s_lshl_b32 s69, s66, 7
    s_bfe_u32 s70, s3, 0x10001
    s_lshl_b32 s70, s70, 6
    s_add_u32 s69, s69, s70
    s_add_u32 s69, s69, s73
    s_lshl_b32 s69, s69, 2
    s_add_u32 s69, s69, 16384
    v_lshl_add_u32 v20, v1, 3, s69
    v_lshlrev_b32 v1, 5, v1
    v_lshrrev_b32 v2, 5, v0
    v_lshl_add_u32 v21, v2, 4, v1
    s_mul_i32 s69, s67, 9216
    s_add_u32 s69, s69, 32768
    s_lshr_b32 s78, s3, 2
    s_mul_i32 s71, s78, s59
    s_sub_u32 s70, s59, 1
    s_cmp_eq_u32 s78, 1
    s_cselect_b32 s70, 3, s70
    s_add_u32 s70, s70, s71
    s_lshl_b32 s70, s70, 10
    s_add_u32 s34, s70, s69
    s_min_u32 s70, s3, 6
    s_lshl_b32 s72, s70, 10
    s_add_u32 s35, s72, 156160
    s_add_u32 s70, s70, 2
    s_cmp_gt_u32 s70, s59
    s_cselect_b32 s70, 1024, 0
    s_add_u32 s69, s69, s70
    s_add_u32 s38, s69, s72
    s_sub_u32 s70, s71, 1
    s_max_i32 s70, s70, 0
    s_lshl_b32 s70, s70, 10
    s_add_u32 s70, s70, 156160
    v_add_u32 v30, s70, v21
    s_lshl_b32 s69, s66, 2
    s_and_b32 s70, s3, 3
    s_add_u32 s69, s69, s70
    s_mul_i32 s39, s69, 120832
    s_lshl_b32 s75, s66, 7
    s_add_u32 s69, s74, s71
    s_lshl_b32 s69, s69, 10
    s_add_u32 s39, s39, s69
    s_lshl_b32 s69, s67, 2
    s_add_u32 s75, s75, s69
    s_mul_i32 s69, s73, 49152
    s_add_u32 s32, s76, s69
    s_mul_i32 s33, s52, 12288
    s_mul_i32 s69, s73, 6144
    s_add_u32 s33, s33, s69
    v_lshrrev_b32 v1, 5, v0
    v_bfe_u32 v2, v0, 2, 2
    v_lshl_add_u32 v1, v1, 2, v2
    v_lshlrev_b32 v1, 7, v1
    v_bfe_u32 v2, v0, 3, 1
    v_lshl_add_u32 v1, v2, 6, v1
    v_bfe_u32 v2, v0, 4, 1
    v_lshl_add_u32 v1, v2, 5, v1
    v_and_b32 v2, 3, v0
    v_lshl_add_u32 v31, v2, 3, v1
    s_mul_i32 s1, s52, 12288
    s_lshl_b32 s69, s73, 10
    s_add_u32 s40, s1, s69
    s_min_u32 s70, s52, 1
    s_mul_i32 s70, s70, 6144
    s_mul_i32 s41, s52, 10240
    s_add_u32 s41, s41, s70
    s_add_u32 s42, s41, s69
    s_lshl_b32 s69, s73, 13
    s_add_u32 s43, s76, s69
    s_add_u32 s43, s43, 196608
    s_lshl_b32 s69, s2, 3
    s_add_u32 s69, s69, s3
    s_sub_u32 s70, s69, 1376
    s_cmp_ge_u32 s69, 1376
    s_cselect_b32 s69, s70, s69
    s_cselect_b32 s84, s36, s44
    s_cselect_b32 s85, s37, s45
    s_mov_b32 s86, 1409024
    s_cmov_b32 s86, 524288
    s_mov_b32 s87, 0x20000
    s_lshl_b32 s46, s69, 10
    s_add_u32 s46, s46, 0
    v_and_b32 v18, 7, v0
    v_lshlrev_b32 v18, 7, v18
    v_mov_b32 v17, 0
    s_waitcnt vmcnt(6)
    v_mov_b32 v52, 0
    v_mov_b32 v53, 0
    v_dot2c_f32_bf16 v52, s62, v48
    v_dot2c_f32_bf16 v53, v48, v48
    v_dot2c_f32_bf16 v52, s62, v49
    v_dot2c_f32_bf16 v53, v49, v49
    v_dot2c_f32_bf16 v52, s62, v50
    v_dot2c_f32_bf16 v53, v50, v50
    v_dot2c_f32_bf16 v52, s62, v51
    v_dot2c_f32_bf16 v53, v51, v51
    s_add_u32 m0, s60, s57
    s_nop 0
    buffer_load_dwordx4 v6, s[8:11], s55 offen lds
    v_add_f32_dpp v52, v52, v52 row_ror:1 row_mask:0xf bank_mask:0xf
    v_add_f32_dpp v53, v53, v53 row_ror:1 row_mask:0xf bank_mask:0xf
    s_nop 0
    v_add_f32_dpp v52, v52, v52 row_ror:2 row_mask:0xf bank_mask:0xf
    v_add_f32_dpp v53, v53, v53 row_ror:2 row_mask:0xf bank_mask:0xf
    s_nop 0
    v_add_f32_dpp v52, v52, v52 row_ror:4 row_mask:0xf bank_mask:0xf
    v_add_f32_dpp v53, v53, v53 row_ror:4 row_mask:0xf bank_mask:0xf
    s_nop 0
    v_add_f32_dpp v52, v52, v52 row_ror:8 row_mask:0xf bank_mask:0xf
    v_add_f32_dpp v53, v53, v53 row_ror:8 row_mask:0xf bank_mask:0xf
    v_mov_b32 v54, v52
    v_mov_b32 v55, v53
    buffer_load_dwordx4 v7, s[8:11], s55 offen offset:1024 lds
    v_permlane16_swap_b32 v52, v54
    v_permlane16_swap_b32 v53, v55
    v_add_f32 v52, v52, v54
    v_add_f32 v53, v53, v55
    v_mov_b32 v54, v52
    v_mov_b32 v55, v53
    s_nop 0
    v_permlane32_swap_b32 v52, v54
    v_permlane32_swap_b32 v53, v55
    v_add_f32 v52, v52, v54
    v_add_f32 v53, v53, v55
    buffer_load_dwordx4 v8, s[8:11], s55 offen offset:2048 lds
    v_mul_f32 v52, 989855744, v52
    v_mul_f32 v53, 989855744, v53
    v_fma_f32 v53, -v52, v52, v53
    v_max_f32 v53, 0, v53
    v_cvt_pk_bf16_f32 v53, v53, v53
    v_lshlrev_b32 v53, 16, v53
    v_add_f32 v53, 925353388, v53
    v_cvt_pk_bf16_f32 v53, v53, v53
    v_lshlrev_b32 v53, 16, v53
    v_sqrt_f32 v53, v53
    buffer_load_dwordx4 v9, s[8:11], s55 offen offset:3072 lds
    s_lshl_b32 s69, s2, 5
    s_lshl_b32 s70, s3, 2
    s_add_u32 s69, s69, s70
    s_add_u32 s69, s69, 16384
    v_cvt_pk_bf16_f32 v53, -v52, v53
    s_mov_b64 exec, 1
    buffer_store_dword v53, off, s[80:83], s69 sc1
    s_mov_b64 exec, -1
    s_cmp_lt_u32 s3, 4
    s_cbranch_scc1 L_no53
    s_add_u32 m0, m0, 4096
    s_nop 0
    buffer_load_dwordx4 v10, s[8:11], s55 offen lds
L_no53:
    s_add_u32 m0, s60, s56
    s_nop 0
    buffer_load_dwordx4 v4, s[4:7], s54 offen lds
    buffer_load_dwordx4 v5, s[4:7], s54 offen offset:1024 lds
    s_add_u32 s60, s60, 53504
    s_cmp_eq_u32 s60, 160512
    s_cselect_b32 s60, 0, s60
    s_lshl_b32 s54, s49, 7
    s_add_u32 s54, s54, s50
    s_mul_i32 s55, s49, s53
    s_add_u32 s55, s55, s51
    s_add_u32 s49, s49, 1
    s_and_b32 s49, s49, 7
    global_load_dword v24, v17, s[28:29] sc1
    s_mul_i32 s45, s53, -7
    s_mov_b32 s49, 15
    s_and_b32 s0, s0, 62
    s_or_b32 s0, s0, 64
    s_ff1_i32_b32 s63, s0
    s_mov_b32 s77, 53504
    s_mov_b32 s37, 4294860288
    v_mov_b32 v52, 0
    v_mov_b32 v53, 0
    v_mov_b32 v54, 0
    v_mov_b32 v55, 0
    s_waitcnt vmcnt(10)
    s_barrier
    s_bitcmp1_b32 s66, 0
    s_cbranch_scc1 L_nocs
    ds_read_b64_tr_b16 v[56:57], v33 offset:0
    ds_read_b64_tr_b16 v[58:59], v33 offset:2304
    ds_read_b64_tr_b16 v[60:61], v33 offset:4608
    ds_read_b64_tr_b16 v[62:63], v33 offset:6912
    ds_read_b64_tr_b16 v[64:65], v33 offset:9216
    ds_read_b64_tr_b16 v[66:67], v33 offset:11520
    ds_read_b64_tr_b16 v[68:69], v33 offset:13824
    ds_read_b64_tr_b16 v[70:71], v33 offset:16128
    ds_read_b64_tr_b16 v[72:73], v34 offset:256
    ds_read_b64_tr_b16 v[74:75], v34 offset:4864
    ds_read_b64_tr_b16 v[76:77], v34 offset:9472
    ds_read_b64_tr_b16 v[78:79], v34 offset:14080
    s_waitcnt lgkmcnt(10)
    v_dot2c_f32_bf16 v52, s62, v56
    v_dot2c_f32_bf16 v54, s62, v57
    v_dot2c_f32_bf16 v52, s62, v58
    v_dot2c_f32_bf16 v54, s62, v59
    s_waitcnt lgkmcnt(8)
    v_dot2c_f32_bf16 v52, s62, v60
    v_dot2c_f32_bf16 v54, s62, v61
    v_dot2c_f32_bf16 v52, s62, v62
    v_dot2c_f32_bf16 v54, s62, v63
    s_waitcnt lgkmcnt(6)
    v_dot2c_f32_bf16 v52, s62, v64
    v_dot2c_f32_bf16 v54, s62, v65
    v_dot2c_f32_bf16 v52, s62, v66
    v_dot2c_f32_bf16 v54, s62, v67
    s_waitcnt lgkmcnt(4)
    v_dot2c_f32_bf16 v52, s62, v68
    v_dot2c_f32_bf16 v54, s62, v69
    v_dot2c_f32_bf16 v52, s62, v70
    v_dot2c_f32_bf16 v54, s62, v71
    s_waitcnt lgkmcnt(0)
    v_dot2c_f32_bf16 v53, s62, v72
    v_dot2c_f32_bf16 v55, s62, v73
    v_dot2c_f32_bf16 v53, s62, v74
    v_dot2c_f32_bf16 v55, s62, v75
    v_dot2c_f32_bf16 v53, s62, v76
    v_dot2c_f32_bf16 v55, s62, v77
    v_dot2c_f32_bf16 v53, s62, v78
    v_dot2c_f32_bf16 v55, s62, v79
    v_add_f32 v52, v52, v54
    s_nop 1
    v_add_f32 v53, v53, v55
    v_mov_b32 v54, v52
    v_mov_b32 v55, v53
    s_nop 0
    v_permlane32_swap_b32 v52, v54
    v_permlane32_swap_b32 v53, v55
    v_add_f32 v52, v52, v54
    v_add_f32 v53, v53, v55
    v_mov_b32 v55, v53
    s_nop 1
    v_permlane16_swap_b32 v53, v55
    v_add_f32 v53, v53, v55
    v_cvt_pk_bf16_f32 v54, v52, v52
    v_lshlrev_b32 v54, 16, v54
    v_sub_f32 v54, v52, v54
    v_cvt_pk_bf16_f32 v52, v52, v54
    v_cvt_pk_bf16_f32 v55, v53, v53
    v_lshlrev_b32 v55, 16, v55
    v_sub_f32 v55, v53, v55
    v_cvt_pk_bf16_f32 v53, v53, v55
    buffer_store_dword v52, v35, s[80:83], 0 offen sc1
    buffer_store_dword v53, v32, s[80:83], 0 offen sc1
L_nocs:
    s_waitcnt vmcnt(8)
    s_barrier
    s_lshr_b32 s69, s3, 2
    s_add_u32 s69, s69, 4
    s_cmp_lt_u32 s69, s59
    s_cbranch_scc0 L_f4
    ds_read_b64_tr_b16 a[0:1], v15 offset:0
    ds_read_b64_tr_b16 a[2:3], v15 offset:1152
    ds_read_b64_tr_b16 a[4:5], v15 offset:32
    ds_read_b64_tr_b16 a[6:7], v15 offset:1184
    ds_read_b128 a[40:43], v11
    s_add_u32 m0, s60, s56
    s_nop 0
    buffer_load_dwordx4 v4, s[4:7], s54 offen lds
    ds_read_b64_tr_b16 a[8:9], v15 offset:64
    ds_read_b64_tr_b16 a[10:11], v15 offset:1216
    ds_read_b64_tr_b16 a[12:13], v15 offset:96
    ds_read_b64_tr_b16 a[14:15], v15 offset:1248
    ds_read_b64_tr_b16 a[16:17], v15 offset:128
    ds_read_b64_tr_b16 a[18:19], v15 offset:1280
    ds_read_b64_tr_b16 a[20:21], v15 offset:4608
    ds_read_b64_tr_b16 a[22:23], v15 offset:5760
    buffer_load_dwordx4 v5, s[4:7], s54 offen offset:1024 lds
    ds_read_b64_tr_b16 a[24:25], v15 offset:4640
    ds_read_b64_tr_b16 a[26:27], v15 offset:5792
    ds_read_b64_tr_b16 a[28:29], v15 offset:4672
    ds_read_b64_tr_b16 a[30:31], v15 offset:5824
    ds_read_b128 a[44:47], v12
    ds_read_b64_tr_b16 a[32:33], v15 offset:4704
    ds_read_b64_tr_b16 a[34:35], v15 offset:5856
    s_add_u32 m0, s60, s57
    s_nop 0
    buffer_load_dwordx4 v6, s[8:11], s55 offen lds
L_f5loop:
    s_waitcnt lgkmcnt(15)
    v_mfma_f32_32x32x16_bf16 v[80:95], a[0:3], a[40:43], v[80:95]
    ds_read_b64_tr_b16 a[36:37], v15 offset:4736
    ds_read_b64_tr_b16 a[38:39], v15 offset:5888
    s_cmp_eq_u32 s60, s77
    s_cselect_b32 s61, s37, s77
    s_add_u32 s54, s54, 128
    s_and_b32 s71, s54, 1023
    s_or_b32 s54, s71, s50
    v_mfma_f32_32x32x16_bf16 v[96:111], a[4:7], a[40:43], v[96:111]
    ds_read_b64_tr_b16 a[0:1], v15 offset:9216
    ds_read_b64_tr_b16 a[2:3], v15 offset:10368
    v_add_u32 v11, s61, v11
    s_waitcnt lgkmcnt(15)
    v_mfma_f32_32x32x16_bf16 v[112:127], a[8:11], a[40:43], v[112:127]
    ds_read_b64_tr_b16 a[4:5], v15 offset:9248
    ds_read_b64_tr_b16 a[6:7], v15 offset:10400
    ds_read_b128 a[48:51], v13
    buffer_load_dwordx4 v7, s[8:11], s55 offen offset:1024 lds
    v_add_u32 v12, s61, v12
    v_mfma_f32_32x32x16_bf16 v[128:143], a[12:15], a[40:43], v[128:143]
    ds_read_b64_tr_b16 a[8:9], v15 offset:9280
    ds_read_b64_tr_b16 a[10:11], v15 offset:10432
    s_waitcnt lgkmcnt(11)
    v_mfma_f32_32x32x16_bf16 v[144:159], a[16:19], a[40:43], v[144:159]
    ds_read_b64_tr_b16 a[12:13], v15 offset:9312
    ds_read_b64_tr_b16 a[14:15], v15 offset:10464
    v_add_u32 v13, s61, v13
    v_mfma_f32_32x32x16_bf16 v[80:95], a[20:23], a[44:47], v[80:95]
    ds_read_b64_tr_b16 a[16:17], v15 offset:9344
    ds_read_b64_tr_b16 a[18:19], v15 offset:10496
    buffer_load_dwordx4 v8, s[8:11], s55 offen offset:2048 lds
    v_mfma_f32_32x32x16_bf16 v[96:111], a[24:27], a[44:47], v[96:111]
    ds_read_b64_tr_b16 a[20:21], v15 offset:13824
    ds_read_b64_tr_b16 a[22:23], v15 offset:14976
    ds_read_b128 a[52:55], v14
    v_mfma_f32_32x32x16_bf16 v[112:127], a[28:31], a[44:47], v[112:127]
    ds_read_b64_tr_b16 a[24:25], v15 offset:13856
    ds_read_b64_tr_b16 a[26:27], v15 offset:15008
    s_waitcnt lgkmcnt(15)
    v_mfma_f32_32x32x16_bf16 v[128:143], a[32:35], a[44:47], v[128:143]
    ds_read_b64_tr_b16 a[28:29], v15 offset:13888
    ds_read_b64_tr_b16 a[30:31], v15 offset:15040
    buffer_load_dwordx4 v9, s[8:11], s55 offen offset:3072 lds
    v_mfma_f32_32x32x16_bf16 v[144:159], a[36:39], a[44:47], v[144:159]
    ds_read_b64_tr_b16 a[32:33], v15 offset:13920
    ds_read_b64_tr_b16 a[34:35], v15 offset:15072
    s_waitcnt lgkmcnt(15)
    v_mfma_f32_32x32x16_bf16 v[80:95], a[0:3], a[48:51], v[80:95]
    ds_read_b64_tr_b16 a[36:37], v15 offset:13952
    ds_read_b64_tr_b16 a[38:39], v15 offset:15104
    s_cmp_eq_u32 s71, 0
    s_cselect_b32 s72, s45, s53
    s_add_u32 s55, s55, s72
    s_cmp_eq_u32 s60, 107008
    s_cselect_b32 s72, s37, s77
    s_add_u32 s60, s60, s72
    v_add_u32 v14, s61, v14
    v_add_u32 v15, s61, v15
    v_mfma_f32_32x32x16_bf16 v[96:111], a[4:7], a[48:51], v[96:111]
    s_add_u32 s48, s48, 1
    s_cmp_lt_u32 s48, s63
    s_waitcnt vmcnt(6) lgkmcnt(0)
    v_mfma_f32_32x32x16_bf16 v[112:127], a[8:11], a[48:51], v[112:127]
    s_cbranch_scc0 L_f5exit
    s_barrier
L_f5back:
    v_mfma_f32_32x32x16_bf16 v[128:143], a[12:15], a[48:51], v[128:143]
    ds_read_b64_tr_b16 a[0:1], v15 offset:0
    ds_read_b64_tr_b16 a[2:3], v15 offset:1152
    ds_read_b64_tr_b16 a[4:5], v15 offset:32
    ds_read_b64_tr_b16 a[6:7], v15 offset:1184
    ds_read_b128 a[40:43], v11
    s_add_u32 m0, s60, s56
    s_nop 0
    buffer_load_dwordx4 v4, s[4:7], s54 offen lds
    v_mfma_f32_32x32x16_bf16 v[144:159], a[16:19], a[48:51], v[144:159]
    ds_read_b64_tr_b16 a[8:9], v15 offset:64
    ds_read_b64_tr_b16 a[10:11], v15 offset:1216
    ds_read_b64_tr_b16 a[12:13], v15 offset:96
    ds_read_b64_tr_b16 a[14:15], v15 offset:1248
    v_mfma_f32_32x32x16_bf16 v[80:95], a[20:23], a[52:55], v[80:95]
    ds_read_b64_tr_b16 a[16:17], v15 offset:128
    ds_read_b64_tr_b16 a[18:19], v15 offset:1280
    v_mfma_f32_32x32x16_bf16 v[96:111], a[24:27], a[52:55], v[96:111]
    ds_read_b64_tr_b16 a[20:21], v15 offset:4608
    ds_read_b64_tr_b16 a[22:23], v15 offset:5760
    buffer_load_dwordx4 v5, s[4:7], s54 offen offset:1024 lds
    v_mfma_f32_32x32x16_bf16 v[112:127], a[28:31], a[52:55], v[112:127]
    ds_read_b64_tr_b16 a[24:25], v15 offset:4640
    ds_read_b64_tr_b16 a[26:27], v15 offset:5792
    v_mfma_f32_32x32x16_bf16 v[128:143], a[32:35], a[52:55], v[128:143]
    ds_read_b64_tr_b16 a[28:29], v15 offset:4672
    ds_read_b64_tr_b16 a[30:31], v15 offset:5824
    ds_read_b128 a[44:47], v12
    v_mfma_f32_32x32x16_bf16 v[144:159], a[36:39], a[52:55], v[144:159]
    ds_read_b64_tr_b16 a[32:33], v15 offset:4704
    ds_read_b64_tr_b16 a[34:35], v15 offset:5856
    s_add_u32 m0, s60, s57
    s_nop 0
    buffer_load_dwordx4 v6, s[8:11], s55 offen lds
    s_branch L_f5loop
L_f5exit:
    s_barrier
    s_cmp_lt_u32 s48, 6
    s_cbranch_scc1 L_f5h
    v_mfma_f32_32x32x16_bf16 v[128:143], a[12:15], a[48:51], v[128:143]
    ds_read_b64_tr_b16 a[0:1], v15 offset:0
    ds_read_b64_tr_b16 a[2:3], v15 offset:1152
    ds_read_b64_tr_b16 a[4:5], v15 offset:32
    ds_read_b64_tr_b16 a[6:7], v15 offset:1184
    ds_read_b128 a[40:43], v11
    v_readfirstlane_b32 s68, v24
    s_mov_b32 s69, 0
L_tagf5:
    s_nop 2
    s_cmp_lg_u32 s68, 0
    s_cbranch_scc1 L_tagokf5
    v_mov_b32 v1, 0
    global_load_dword v24, v1, s[28:29] sc1
    s_waitcnt vmcnt(0)
    v_readfirstlane_b32 s68, v24
    s_add_u32 s69, s69, 1
    s_cmp_lt_u32 s69, 262144
    s_cbranch_scc1 L_tagf5
L_tagokf5:
    s_mov_b32 s54, s32
    s_mov_b32 s56, s33
    buffer_load_dword v24, v22, s[80:83], 0 offen sc1
    s_add_u32 m0, s60, s56
    s_nop 0
    buffer_load_dwordx4 v25, s[16:19], s54 offen lds
    v_mfma_f32_32x32x16_bf16 v[144:159], a[16:19], a[48:51], v[144:159]
    ds_read_b64_tr_b16 a[8:9], v15 offset:64
    ds_read_b64_tr_b16 a[10:11], v15 offset:1216
    ds_read_b64_tr_b16 a[12:13], v15 offset:96
    ds_read_b64_tr_b16 a[14:15], v15 offset:1248
    v_mfma_f32_32x32x16_bf16 v[80:95], a[20:23], a[52:55], v[80:95]
    ds_read_b64_tr_b16 a[16:17], v15 offset:128
    ds_read_b64_tr_b16 a[18:19], v15 offset:1280
    v_mfma_f32_32x32x16_bf16 v[96:111], a[24:27], a[52:55], v[96:111]
    ds_read_b64_tr_b16 a[20:21], v15 offset:4608
    ds_read_b64_tr_b16 a[22:23], v15 offset:5760
    buffer_load_dwordx4 v26, s[16:19], s54 offen offset:1024 lds
    v_mfma_f32_32x32x16_bf16 v[112:127], a[28:31], a[52:55], v[112:127]
    ds_read_b64_tr_b16 a[24:25], v15 offset:4640
    ds_read_b64_tr_b16 a[26:27], v15 offset:5792
    v_mfma_f32_32x32x16_bf16 v[128:143], a[32:35], a[52:55], v[128:143]
    ds_read_b64_tr_b16 a[28:29], v15 offset:4672
    ds_read_b64_tr_b16 a[30:31], v15 offset:5824
    ds_read_b128 a[44:47], v12
    v_mfma_f32_32x32x16_bf16 v[144:159], a[36:39], a[52:55], v[144:159]
    ds_read_b64_tr_b16 a[32:33], v15 offset:4704
    ds_read_b64_tr_b16 a[34:35], v15 offset:5856
    buffer_load_dwordx4 v27, s[16:19], s54 offen offset:2048 lds
L_f5tail:
    s_waitcnt lgkmcnt(15)
    v_mfma_f32_32x32x16_bf16 v[80:95], a[0:3], a[40:43], v[80:95]
    ds_read_b64_tr_b16 a[36:37], v15 offset:4736
    ds_read_b64_tr_b16 a[38:39], v15 offset:5888
    s_cmp_eq_u32 s60, s77
    s_cselect_b32 s61, s37, s77
    v_mfma_f32_32x32x16_bf16 v[96:111], a[4:7], a[40:43], v[96:111]
    ds_read_b64_tr_b16 a[0:1], v15 offset:9216
    ds_read_b64_tr_b16 a[2:3], v15 offset:10368
    v_add_u32 v11, s61, v11
    s_waitcnt lgkmcnt(15)
    v_mfma_f32_32x32x16_bf16 v[112:127], a[8:11], a[40:43], v[112:127]
    ds_read_b64_tr_b16 a[4:5], v15 offset:9248
    ds_read_b64_tr_b16 a[6:7], v15 offset:10400
    ds_read_b128 a[48:51], v13
    buffer_load_dwordx4 v28, s[16:19], s54 offen offset:3072 lds
    v_add_u32 v12, s61, v12
    v_mfma_f32_32x32x16_bf16 v[128:143], a[12:15], a[40:43], v[128:143]
    ds_read_b64_tr_b16 a[8:9], v15 offset:9280
    ds_read_b64_tr_b16 a[10:11], v15 offset:10432
    s_waitcnt lgkmcnt(11)
    v_mfma_f32_32x32x16_bf16 v[144:159], a[16:19], a[40:43], v[144:159]
    ds_read_b64_tr_b16 a[12:13], v15 offset:9312
    ds_read_b64_tr_b16 a[14:15], v15 offset:10464
    v_add_u32 v13, s61, v13
    v_mfma_f32_32x32x16_bf16 v[80:95], a[20:23], a[44:47], v[80:95]
    ds_read_b64_tr_b16 a[16:17], v15 offset:9344
    ds_read_b64_tr_b16 a[18:19], v15 offset:10496
    s_add_u32 m0, m0, 4096
    s_add_u32 s54, s54, 32768
    buffer_load_dwordx4 v25, s[16:19], s54 offen lds
    v_mfma_f32_32x32x16_bf16 v[96:111], a[24:27], a[44:47], v[96:111]
    ds_read_b64_tr_b16 a[20:21], v15 offset:13824
    ds_read_b64_tr_b16 a[22:23], v15 offset:14976
    ds_read_b128 a[52:55], v14
    v_mfma_f32_32x32x16_bf16 v[112:127], a[28:31], a[44:47], v[112:127]
    ds_read_b64_tr_b16 a[24:25], v15 offset:13856
    ds_read_b64_tr_b16 a[26:27], v15 offset:15008
    s_waitcnt lgkmcnt(15)
    v_mfma_f32_32x32x16_bf16 v[128:143], a[32:35], a[44:47], v[128:143]
    ds_read_b64_tr_b16 a[28:29], v15 offset:13888
    ds_read_b64_tr_b16 a[30:31], v15 offset:15040
    buffer_load_dwordx4 v26, s[16:19], s54 offen offset:1024 lds
    s_add_u32 s54, s54, 65536
    v_mfma_f32_32x32x16_bf16 v[144:159], a[36:39], a[44:47], v[144:159]
    ds_read_b64_tr_b16 a[32:33], v15 offset:13920
    ds_read_b64_tr_b16 a[34:35], v15 offset:15072
    s_waitcnt lgkmcnt(15)
    v_mfma_f32_32x32x16_bf16 v[80:95], a[0:3], a[48:51], v[80:95]
    ds_read_b64_tr_b16 a[36:37], v15 offset:13952
    ds_read_b64_tr_b16 a[38:39], v15 offset:15104
    s_cmp_eq_u32 s60, 107008
    s_cselect_b32 s72, s37, s77
    s_add_u32 s60, s60, s72
    v_add_u32 v14, s61, v14
    v_add_u32 v15, s61, v15
    v_mfma_f32_32x32x16_bf16 v[96:111], a[4:7], a[48:51], v[96:111]
    s_add_u32 s48, s48, 1
    s_cmp_lt_u32 s48, 8
    s_waitcnt vmcnt(6) lgkmcnt(0)
    v_mfma_f32_32x32x16_bf16 v[112:127], a[8:11], a[48:51], v[112:127]
    s_cbranch_scc0 L_f5texit
    s_barrier
    v_mfma_f32_32x32x16_bf16 v[128:143], a[12:15], a[48:51], v[128:143]
    ds_read_b64_tr_b16 a[0:1], v15 offset:0
    ds_read_b64_tr_b16 a[2:3], v15 offset:1152
    ds_read_b64_tr_b16 a[4:5], v15 offset:32
    ds_read_b64_tr_b16 a[6:7], v15 offset:1184
    ds_read_b128 a[40:43], v11
    s_mov_b32 s69, 0
L_f0f5:
    v_cmp_ne_u32 vcc, s68, v24
    s_nop 3
    s_cbranch_vccz L_f0okf5
    buffer_load_dword v24, v22, s[80:83], 0 offen sc1
    s_waitcnt vmcnt(0)
    s_add_u32 s69, s69, 1
    s_cmp_lt_u32 s69, 262144
    s_cbranch_scc1 L_f0f5
L_f0okf5:
    buffer_load_dword v16, v20, s[80:83], 0 offen sc1
    s_mov_b32 m0, s35
    buffer_load_dwordx4 v[40:43], v21, s[80:83], s34 offen sc1
    buffer_load_dwordx4 v29, s[80:83], s38 offen sc1 lds
    s_add_u32 m0, s60, s56
    s_nop 0
    buffer_load_dwordx4 v25, s[16:19], s54 offen lds
    v_mfma_f32_32x32x16_bf16 v[144:159], a[16:19], a[48:51], v[144:159]
    ds_read_b64_tr_b16 a[8:9], v15 offset:64
    ds_read_b64_tr_b16 a[10:11], v15 offset:1216
    ds_read_b64_tr_b16 a[12:13], v15 offset:96
    ds_read_b64_tr_b16 a[14:15], v15 offset:1248
    v_mfma_f32_32x32x16_bf16 v[80:95], a[20:23], a[52:55], v[80:95]
    ds_read_b64_tr_b16 a[16:17], v15 offset:128
    ds_read_b64_tr_b16 a[18:19], v15 offset:1280
    v_mfma_f32_32x32x16_bf16 v[96:111], a[24:27], a[52:55], v[96:111]
    ds_read_b64_tr_b16 a[20:21], v15 offset:4608
    ds_read_b64_tr_b16 a[22:23], v15 offset:5760
    buffer_load_dwordx4 v26, s[16:19], s54 offen offset:1024 lds
    v_mfma_f32_32x32x16_bf16 v[112:127], a[28:31], a[52:55], v[112:127]
    ds_read_b64_tr_b16 a[24:25], v15 offset:4640
    ds_read_b64_tr_b16 a[26:27], v15 offset:5792
    v_mfma_f32_32x32x16_bf16 v[128:143], a[32:35], a[52:55], v[128:143]
    ds_read_b64_tr_b16 a[28:29], v15 offset:4672
    ds_read_b64_tr_b16 a[30:31], v15 offset:5824
    ds_read_b128 a[44:47], v12
    v_mfma_f32_32x32x16_bf16 v[144:159], a[36:39], a[52:55], v[144:159]
    ds_read_b64_tr_b16 a[32:33], v15 offset:4704
    ds_read_b64_tr_b16 a[34:35], v15 offset:5856
    buffer_load_dwordx4 v27, s[16:19], s54 offen offset:2048 lds
    s_branch L_f5tail
L_f5texit:
    s_barrier
    ds_read_b128 v[44:47], v30 offset:0
    ds_read_b128 v[48:51], v30 offset:1024
    ds_read_b128 v[32:35], v30 offset:2048
    ds_read_b128 v[12:15], v30 offset:3072
    v_mfma_f32_32x32x16_bf16 v[128:143], a[12:15], a[48:51], v[128:143]
    v_and_b32 v1, 0xffff, v16
    v_and_b32 v16, 0xffff0000, v16
    v_lshl_or_b32 v36, v1, 16, v1
    v_rcp_f32 v18, v16
    v_mfma_f32_32x32x16_bf16 v[144:159], a[16:19], a[48:51], v[144:159]
    v_mov_b32 v37, v36
    v_mov_b32 v38, v36
    v_mov_b32 v39, v36
    v_mul_f32 v20, v16, v16
    v_mfma_f32_32x32x16_bf16 v[80:95], a[20:23], a[52:55], v[80:95]
    v_mul_f32 v22, v16, v16
    v_mul_f32 v18, 3216550459, v18
    v_mov_b32 v10, v31
    v_add_u32 v4, s1, v31
    v_add_u32 v6, 107008, v4
    v_xor_b32 v7, 64, v6
    v_add_u32 v11, 14336, v25
    s_mov_b32 s74, 1
    s_waitcnt lgkmcnt(0)
    v_mfma_f32_32x32x16_bf16 v[80:95], v[44:47], v[36:39], v[80:95]
    v_mfma_f32_32x32x16_bf16 v[96:111], a[24:27], a[52:55], v[96:111]
    s_add_u32 m0, s40, 53504
    s_nop 0
    buffer_load_dwordx4 v25, s[16:19], s43 offen lds
    v_mfma_f32_32x32x16_bf16 v[96:111], v[48:51], v[36:39], v[96:111]
    buffer_load_dwordx4 v11, s[16:19], s43 offen offset:2048 lds
    s_nop 5
    v_mul_f32 v52, v18, v80
    v_mul_f32 v53, v18, v81
    v_mul_f32 v54, v18, v82
    v_mul_f32 v55, v18, v83
    v_mul_f32 v56, v18, v84
    v_mul_f32 v57, v18, v85
    v_mul_f32 v58, v18, v86
    v_mul_f32 v59, v18, v87
    v_mfma_f32_32x32x16_bf16 v[112:127], a[28:31], a[52:55], v[112:127]
    s_add_u32 s43, s43, 32768
    s_add_u32 m0, s40, 57600
    s_nop 0
    buffer_load_dwordx4 v25, s[16:19], s43 offen lds
    v_exp_f32 v52, v52
    v_exp_f32 v53, v53
    v_exp_f32 v54, v54
    v_exp_f32 v55, v55
    v_exp_f32 v56, v56
    v_exp_f32 v57, v57
    v_exp_f32 v58, v58
    v_exp_f32 v59, v59
    v_mfma_f32_32x32x16_bf16 v[112:127], v[32:35], v[36:39], v[112:127]
    buffer_load_dwordx4 v11, s[16:19], s43 offen offset:2048 lds
    v_mul_f32 v60, v80, v88
    v_mul_f32 v61, v81, v89
    v_mul_f32 v62, v82, v90
    v_mul_f32 v63, v83, v91
    v_mul_f32 v64, v84, v92
    v_mul_f32 v65, v85, v93
    v_mul_f32 v66, v86, v94
    v_mul_f32 v67, v87, v95
    v_mfma_f32_32x32x16_bf16 v[128:143], a[32:35], a[52:55], v[128:143]
    s_add_u32 s43, s43, 32768
    s_add_u32 m0, s40, 61696
    s_nop 0
    buffer_load_dwordx4 v25, s[16:19], s43 offen lds
    v_fma_f32 v52, v52, v20, v20
    v_fma_f32 v53, v53, v20, v20
    v_fma_f32 v54, v54, v20, v20
    v_fma_f32 v55, v55, v20, v20
    v_fma_f32 v56, v56, v20, v20
    v_fma_f32 v57, v57, v20, v20
    v_fma_f32 v58, v58, v20, v20
    v_fma_f32 v59, v59, v20, v20
    v_mfma_f32_32x32x16_bf16 v[128:143], v[12:15], v[36:39], v[128:143]
    buffer_load_dwordx4 v11, s[16:19], s43 offen offset:2048 lds
    v_rcp_f32 v52, v52
    v_rcp_f32 v53, v53
    v_rcp_f32 v54, v54
    v_rcp_f32 v55, v55
    v_rcp_f32 v56, v56
    v_rcp_f32 v57, v57
    v_rcp_f32 v58, v58
    v_rcp_f32 v59, v59
    v_mfma_f32_32x32x16_bf16 v[144:159], a[36:39], a[52:55], v[144:159]
    v_mul_f32 v52, v52, v60
    v_mul_f32 v53, v53, v61
    v_mul_f32 v54, v54, v62
    v_mul_f32 v55, v55, v63
    v_mul_f32 v56, v56, v64
    v_mul_f32 v57, v57, v65
    v_mul_f32 v58, v58, v66
    v_mul_f32 v59, v59, v67
    v_mfma_f32_32x32x16_bf16 v[144:159], v[40:43], v[36:39], v[144:159]
    v_cvt_pk_bf16_f32 v68, v52, v53
    v_cvt_pk_bf16_f32 v69, v54, v55
    v_cvt_pk_bf16_f32 v70, v56, v57
    v_cvt_pk_bf16_f32 v71, v58, v59
    buffer_store_dwordx4 v[68:71], v29, s[12:15], s39 offen sc1
    v_pk_mul_f32 v[52:53], v[96:97], v[18:19] op_sel_hi:[1,0]
    v_pk_mul_f32 v[54:55], v[98:99], v[18:19] op_sel_hi:[1,0]
    v_pk_mul_f32 v[56:57], v[100:101], v[18:19] op_sel_hi:[1,0]
    v_pk_mul_f32 v[58:59], v[102:103], v[18:19] op_sel_hi:[1,0]
    v_exp_f32 v52, v52
    v_exp_f32 v53, v53
    v_exp_f32 v54, v54
    v_exp_f32 v55, v55
    v_exp_f32 v56, v56
    v_exp_f32 v57, v57
    v_exp_f32 v58, v58
    v_exp_f32 v59, v59
    v_pk_mul_f32 v[60:61], v[96:97], v[104:105]
    v_pk_mul_f32 v[62:63], v[98:99], v[106:107]
    v_pk_mul_f32 v[64:65], v[100:101], v[108:109]
    v_pk_mul_f32 v[66:67], v[102:103], v[110:111]
    v_pk_fma_f32 v[52:53], v[52:53], v[20:21], v[22:23] op_sel_hi:[1,0,0]
    v_pk_fma_f32 v[54:55], v[54:55], v[20:21], v[22:23] op_sel_hi:[1,0,0]
    v_pk_fma_f32 v[56:57], v[56:57], v[20:21], v[22:23] op_sel_hi:[1,0,0]
    v_pk_fma_f32 v[58:59], v[58:59], v[20:21], v[22:23] op_sel_hi:[1,0,0]
    v_rcp_f32 v52, v52
    v_rcp_f32 v53, v53
    v_rcp_f32 v54, v54
    v_rcp_f32 v55, v55
    v_rcp_f32 v56, v56
    v_rcp_f32 v57, v57
    v_rcp_f32 v58, v58
    v_rcp_f32 v59, v59
    v_pk_mul_f32 v[52:53], v[52:53], v[60:61]
    v_pk_mul_f32 v[54:55], v[54:55], v[62:63]
    v_pk_mul_f32 v[56:57], v[56:57], v[64:65]
    v_pk_mul_f32 v[58:59], v[58:59], v[66:67]
    v_cvt_pk_bf16_f32 v72, v52, v53
    v_cvt_pk_bf16_f32 v73, v54, v55
    v_cvt_pk_bf16_f32 v74, v56, v57
    v_cvt_pk_bf16_f32 v75, v58, v59
    buffer_store_dwordx4 v[72:75], v29, s[12:15], s39 offen offset:1024 sc1
    v_pk_mul_f32 v[52:53], v[112:113], v[18:19] op_sel_hi:[1,0]
    v_pk_mul_f32 v[54:55], v[114:115], v[18:19] op_sel_hi:[1,0]
    v_pk_mul_f32 v[56:57], v[116:117], v[18:19] op_sel_hi:[1,0]
    v_pk_mul_f32 v[58:59], v[118:119], v[18:19] op_sel_hi:[1,0]
    v_exp_f32 v52, v52
    v_exp_f32 v53, v53
    v_exp_f32 v54, v54
    v_exp_f32 v55, v55
    v_exp_f32 v56, v56
    v_exp_f32 v57, v57
    v_exp_f32 v58, v58
    v_exp_f32 v59, v59
    v_pk_mul_f32 v[60:61], v[112:113], v[120:121]
    v_pk_mul_f32 v[62:63], v[114:115], v[122:123]
    v_pk_mul_f32 v[64:65], v[116:117], v[124:125]
    v_pk_mul_f32 v[66:67], v[118:119], v[126:127]
    v_pk_fma_f32 v[52:53], v[52:53], v[20:21], v[22:23] op_sel_hi:[1,0,0]
    v_pk_fma_f32 v[54:55], v[54:55], v[20:21], v[22:23] op_sel_hi:[1,0,0]
    v_pk_fma_f32 v[56:57], v[56:57], v[20:21], v[22:23] op_sel_hi:[1,0,0]
    v_pk_fma_f32 v[58:59], v[58:59], v[20:21], v[22:23] op_sel_hi:[1,0,0]
    v_rcp_f32 v52, v52
    v_rcp_f32 v53, v53
    v_rcp_f32 v54, v54
    v_rcp_f32 v55, v55
    v_rcp_f32 v56, v56
    v_rcp_f32 v57, v57
    v_rcp_f32 v58, v58
    v_rcp_f32 v59, v59
    v_pk_mul_f32 v[52:53], v[52:53], v[60:61]
    v_pk_mul_f32 v[54:55], v[54:55], v[62:63]
    v_pk_mul_f32 v[56:57], v[56:57], v[64:65]
    v_pk_mul_f32 v[58:59], v[58:59], v[66:67]
    v_cvt_pk_bf16_f32 v68, v52, v53
    v_cvt_pk_bf16_f32 v69, v54, v55
    v_cvt_pk_bf16_f32 v70, v56, v57
    v_cvt_pk_bf16_f32 v71, v58, v59
    buffer_store_dwordx4 v[68:71], v29, s[12:15], s39 offen offset:2048 sc1
    v_pk_mul_f32 v[52:53], v[128:129], v[18:19] op_sel_hi:[1,0]
    v_pk_mul_f32 v[54:55], v[130:131], v[18:19] op_sel_hi:[1,0]
    v_pk_mul_f32 v[56:57], v[132:133], v[18:19] op_sel_hi:[1,0]
    v_pk_mul_f32 v[58:59], v[134:135], v[18:19] op_sel_hi:[1,0]
    v_exp_f32 v52, v52
    v_exp_f32 v53, v53
    v_exp_f32 v54, v54
    v_exp_f32 v55, v55
    v_exp_f32 v56, v56
    v_exp_f32 v57, v57
    v_exp_f32 v58, v58
    v_exp_f32 v59, v59
    v_pk_mul_f32 v[60:61], v[128:129], v[136:137]
    v_pk_mul_f32 v[62:63], v[130:131], v[138:139]
    v_pk_mul_f32 v[64:65], v[132:133], v[140:141]
    v_pk_mul_f32 v[66:67], v[134:135], v[142:143]
    v_pk_fma_f32 v[52:53], v[52:53], v[20:21], v[22:23] op_sel_hi:[1,0,0]
    v_pk_fma_f32 v[54:55], v[54:55], v[20:21], v[22:23] op_sel_hi:[1,0,0]
    v_pk_fma_f32 v[56:57], v[56:57], v[20:21], v[22:23] op_sel_hi:[1,0,0]
    v_pk_fma_f32 v[58:59], v[58:59], v[20:21], v[22:23] op_sel_hi:[1,0,0]
    v_rcp_f32 v52, v52
    v_rcp_f32 v53, v53
    v_rcp_f32 v54, v54
    v_rcp_f32 v55, v55
    v_rcp_f32 v56, v56
    v_rcp_f32 v57, v57
    v_rcp_f32 v58, v58
    v_rcp_f32 v59, v59
    v_pk_mul_f32 v[52:53], v[52:53], v[60:61]
    v_pk_mul_f32 v[54:55], v[54:55], v[62:63]
    v_pk_mul_f32 v[56:57], v[56:57], v[64:65]
    v_pk_mul_f32 v[58:59], v[58:59], v[66:67]
    v_cvt_pk_bf16_f32 v72, v52, v53
    v_cvt_pk_bf16_f32 v73, v54, v55
    v_cvt_pk_bf16_f32 v74, v56, v57
    v_cvt_pk_bf16_f32 v75, v58, v59
    buffer_store_dwordx4 v[72:75], v29, s[12:15], s39 offen offset:3072 sc1
    v_pk_mul_f32 v[52:53], v[144:145], v[18:19] op_sel_hi:[1,0]
    v_pk_mul_f32 v[54:55], v[146:147], v[18:19] op_sel_hi:[1,0]
    v_pk_mul_f32 v[56:57], v[148:149], v[18:19] op_sel_hi:[1,0]
    v_pk_mul_f32 v[58:59], v[150:151], v[18:19] op_sel_hi:[1,0]
    v_exp_f32 v52, v52
    v_exp_f32 v53, v53
    v_exp_f32 v54, v54
    v_exp_f32 v55, v55
    v_exp_f32 v56, v56
    v_exp_f32 v57, v57
    v_exp_f32 v58, v58
    v_exp_f32 v59, v59
    v_pk_mul_f32 v[60:61], v[144:145], v[152:153]
    v_pk_mul_f32 v[62:63], v[146:147], v[154:155]
    v_pk_mul_f32 v[64:65], v[148:149], v[156:157]
    v_pk_mul_f32 v[66:67], v[150:151], v[158:159]
    v_pk_fma_f32 v[52:53], v[52:53], v[20:21], v[22:23] op_sel_hi:[1,0,0]
    v_pk_fma_f32 v[54:55], v[54:55], v[20:21], v[22:23] op_sel_hi:[1,0,0]
    v_pk_fma_f32 v[56:57], v[56:57], v[20:21], v[22:23] op_sel_hi:[1,0,0]
    v_pk_fma_f32 v[58:59], v[58:59], v[20:21], v[22:23] op_sel_hi:[1,0,0]
    v_rcp_f32 v52, v52
    v_rcp_f32 v53, v53
    v_rcp_f32 v54, v54
    v_rcp_f32 v55, v55
    v_rcp_f32 v56, v56
    v_rcp_f32 v57, v57
    v_rcp_f32 v58, v58
    v_rcp_f32 v59, v59
    v_pk_mul_f32 v[52:53], v[52:53], v[60:61]
    v_pk_mul_f32 v[54:55], v[54:55], v[62:63]
    v_pk_mul_f32 v[56:57], v[56:57], v[64:65]
    v_pk_mul_f32 v[58:59], v[58:59], v[66:67]
    v_cvt_pk_bf16_f32 v68, v52, v53
    v_cvt_pk_bf16_f32 v69, v54, v55
    v_cvt_pk_bf16_f32 v70, v56, v57
    v_cvt_pk_bf16_f32 v71, v58, v59
    s_add_u32 s39, s39, 4096
    buffer_store_dwordx4 v[68:71], v29, s[12:15], s39 offen sc1
    ds_read_b64_tr_b16 a[0:1], v6 offset:0
    ds_read_b64_tr_b16 a[2:3], v6 offset:1024
    ds_read_b64_tr_b16 a[4:5], v7 offset:0
    ds_read_b64_tr_b16 a[6:7], v7 offset:1024
    ds_read_b64_tr_b16 a[8:9], v6 offset:2048
    ds_read_b64_tr_b16 a[10:11], v6 offset:3072
    ds_read_b64_tr_b16 a[12:13], v7 offset:2048
    ds_read_b64_tr_b16 a[14:15], v7 offset:3072
    ds_read_b64_tr_b16 a[16:17], v6 offset:4096
    ds_read_b64_tr_b16 a[18:19], v6 offset:5120
    ds_read_b64_tr_b16 a[20:21], v7 offset:4096
    ds_read_b64_tr_b16 a[22:23], v7 offset:5120
    ds_read_b64_tr_b16 a[24:25], v6 offset:6144
    ds_read_b64_tr_b16 a[26:27], v6 offset:7168
    ds_read_b64_tr_b16 a[28:29], v7 offset:6144
    ds_read_b64_tr_b16 a[30:31], v7 offset:7168
    ds_read_b64_tr_b16 a[32:33], v6 offset:8192
    ds_read_b64_tr_b16 a[34:35], v6 offset:9216
    ds_read_b64_tr_b16 a[36:37], v7 offset:8192
    ds_read_b64_tr_b16 a[38:39], v7 offset:9216
    ds_read_b64_tr_b16 a[40:41], v6 offset:10240
    ds_read_b64_tr_b16 a[42:43], v6 offset:11264
    ds_read_b64_tr_b16 a[44:45], v7 offset:10240
    ds_read_b64_tr_b16 a[46:47], v7 offset:11264
    s_waitcnt vmcnt(11) lgkmcnt(0)
    s_barrier
    s_branch L_phase2
L_f5h:
    s_bitset0_b32 s0, s48
    s_ff1_i32_b32 s63, s0
    s_cmp_lg_u32 s48, s49
    s_cbranch_scc1 L_f5h0
    s_sub_u32 s54, s54, 1024
    s_lshl_b32 s69, s53, 3
    s_sub_u32 s55, s55, s69
L_f5h0:
    s_cmp_lt_u32 s48, 3
    s_cbranch_scc1 L_f5h1
    buffer_load_dword v19, v18, s[84:87], s46 offen
L_f5h1:
    s_lshl_b32 s69, s3, 3
    s_add_u32 s69, s69, s48
    s_cmp_lg_u32 s69, 1
    s_cbranch_scc1 L_f5back
    v_readfirstlane_b32 s68, v24
    s_mov_b32 s69, 0
L_tagf5h:
    s_nop 2
    s_cmp_lg_u32 s68, 0
    s_cbranch_scc1 L_tagokf5h
    v_mov_b32 v1, 0
    global_load_dword v24, v1, s[28:29] sc1
    s_waitcnt vmcnt(0)
    v_readfirstlane_b32 s68, v24
    s_add_u32 s69, s69, 1
    s_cmp_lt_u32 s69, 262144
    s_cbranch_scc1 L_tagf5h
L_tagokf5h:
    v_mov_b32 v1, s68
    s_mov_b64 exec, 3
    buffer_store_dword v1, v23, s[80:83], 0 offen sc1
    s_mov_b64 exec, -1
    s_branch L_f5back
L_f4:
    ds_read_b64_tr_b16 a[0:1], v15 offset:0
    ds_read_b64_tr_b16 a[2:3], v15 offset:1152
    ds_read_b64_tr_b16 a[4:5], v15 offset:32
    ds_read_b64_tr_b16 a[6:7], v15 offset:1184
    ds_read_b128 a[40:43], v11
    s_add_u32 m0, s60, s56
    s_nop 0
    buffer_load_dwordx4 v4, s[4:7], s54 offen lds
    ds_read_b64_tr_b16 a[8:9], v15 offset:64
    ds_read_b64_tr_b16 a[10:11], v15 offset:1216
    ds_read_b64_tr_b16 a[12:13], v15 offset:96
    ds_read_b64_tr_b16 a[14:15], v15 offset:1248
    ds_read_b64_tr_b16 a[16:17], v15 offset:4608
    ds_read_b64_tr_b16 a[18:19], v15 offset:5760
    buffer_load_dwordx4 v5, s[4:7], s54 offen offset:1024 lds
    ds_read_b64_tr_b16 a[20:21], v15 offset:4640
    ds_read_b64_tr_b16 a[22:23], v15 offset:5792
    ds_read_b128 a[44:47], v12
    ds_read_b64_tr_b16 a[24:25], v15 offset:4672
    ds_read_b64_tr_b16 a[26:27], v15 offset:5824
    s_add_u32 m0, s60, s57
    s_nop 0
    buffer_load_dwordx4 v6, s[8:11], s55 offen lds
L_f4loop:
    s_waitcnt lgkmcnt(11)
    v_mfma_f32_32x32x16_bf16 v[80:95], a[0:3], a[40:43], v[80:95]
    ds_read_b64_tr_b16 a[28:29], v15 offset:4704
    ds_read_b64_tr_b16 a[30:31], v15 offset:5856
    s_cmp_eq_u32 s60, s77
    s_cselect_b32 s61, s37, s77
    v_mfma_f32_32x32x16_bf16 v[96:111], a[4:7], a[40:43], v[96:111]
    ds_read_b64_tr_b16 a[0:1], v15 offset:9216
    ds_read_b64_tr_b16 a[2:3], v15 offset:10368
    buffer_load_dwordx4 v7, s[8:11], s55 offen offset:1024 lds
    v_add_u32 v11, s61, v11
    s_waitcnt lgkmcnt(11)
    v_mfma_f32_32x32x16_bf16 v[112:127], a[8:11], a[40:43], v[112:127]
    ds_read_b64_tr_b16 a[4:5], v15 offset:9248
    ds_read_b64_tr_b16 a[6:7], v15 offset:10400
    ds_read_b128 a[48:51], v13
    s_add_u32 s54, s54, 128
    s_and_b32 s71, s54, 1023
    s_or_b32 s54, s71, s50
    v_add_u32 v12, s61, v12
    v_mfma_f32_32x32x16_bf16 v[128:143], a[12:15], a[40:43], v[128:143]
    ds_read_b64_tr_b16 a[8:9], v15 offset:9280
    ds_read_b64_tr_b16 a[10:11], v15 offset:10432
    buffer_load_dwordx4 v8, s[8:11], s55 offen offset:2048 lds
    s_waitcnt lgkmcnt(11)
    v_mfma_f32_32x32x16_bf16 v[80:95], a[16:19], a[44:47], v[80:95]
    ds_read_b64_tr_b16 a[12:13], v15 offset:9312
    ds_read_b64_tr_b16 a[14:15], v15 offset:10464
    v_add_u32 v13, s61, v13
    v_mfma_f32_32x32x16_bf16 v[96:111], a[20:23], a[44:47], v[96:111]
    ds_read_b64_tr_b16 a[16:17], v15 offset:13824
    ds_read_b64_tr_b16 a[18:19], v15 offset:14976
    ds_read_b128 a[52:55], v14
    buffer_load_dwordx4 v9, s[8:11], s55 offen offset:3072 lds
    s_waitcnt lgkmcnt(12)
    v_mfma_f32_32x32x16_bf16 v[112:127], a[24:27], a[44:47], v[112:127]
    ds_read_b64_tr_b16 a[20:21], v15 offset:13856
    ds_read_b64_tr_b16 a[22:23], v15 offset:15008
    v_mfma_f32_32x32x16_bf16 v[128:143], a[28:31], a[44:47], v[128:143]
    ds_read_b64_tr_b16 a[24:25], v15 offset:13888
    ds_read_b64_tr_b16 a[26:27], v15 offset:15040
    s_cmp_lt_u32 s3, 4
    s_cbranch_scc1 L_no54
    s_add_u32 m0, m0, 4096
    s_nop 0
    buffer_load_dwordx4 v10, s[8:11], s55 offen lds
L_no54:
    s_waitcnt lgkmcnt(11)
    v_mfma_f32_32x32x16_bf16 v[80:95], a[0:3], a[48:51], v[80:95]
    ds_read_b64_tr_b16 a[28:29], v15 offset:13920
    ds_read_b64_tr_b16 a[30:31], v15 offset:15072
    s_cmp_eq_u32 s71, 0
    s_cselect_b32 s72, s45, s53
    s_add_u32 s55, s55, s72
    s_cmp_eq_u32 s60, 107008
    s_cselect_b32 s72, s37, s77
    s_add_u32 s60, s60, s72
    v_add_u32 v14, s61, v14
    v_add_u32 v15, s61, v15
    v_mfma_f32_32x32x16_bf16 v[96:111], a[4:7], a[48:51], v[96:111]
    s_add_u32 s48, s48, 1
    s_cmp_lt_u32 s48, s63
    s_waitcnt vmcnt(6) lgkmcnt(0)
    v_mfma_f32_32x32x16_bf16 v[112:127], a[8:11], a[48:51], v[112:127]
    s_cbranch_scc0 L_f4exit
    s_barrier
L_f4back:
    v_mfma_f32_32x32x16_bf16 v[128:143], a[12:15], a[48:51], v[128:143]
    ds_read_b64_tr_b16 a[0:1], v15 offset:0
    ds_read_b64_tr_b16 a[2:3], v15 offset:1152
    ds_read_b64_tr_b16 a[4:5], v15 offset:32
    ds_read_b64_tr_b16 a[6:7], v15 offset:1184
    ds_read_b128 a[40:43], v11
    s_add_u32 m0, s60, s56
    s_nop 0
    buffer_load_dwordx4 v4, s[4:7], s54 offen lds
    v_mfma_f32_32x32x16_bf16 v[80:95], a[16:19], a[52:55], v[80:95]
    ds_read_b64_tr_b16 a[8:9], v15 offset:64
    ds_read_b64_tr_b16 a[10:11], v15 offset:1216
    ds_read_b64_tr_b16 a[12:13], v15 offset:96
    ds_read_b64_tr_b16 a[14:15], v15 offset:1248
    v_mfma_f32_32x32x16_bf16 v[96:111], a[20:23], a[52:55], v[96:111]
    ds_read_b64_tr_b16 a[16:17], v15 offset:4608
    ds_read_b64_tr_b16 a[18:19], v15 offset:5760
    buffer_load_dwordx4 v5, s[4:7], s54 offen offset:1024 lds
    v_mfma_f32_32x32x16_bf16 v[112:127], a[24:27], a[52:55], v[112:127]
    ds_read_b64_tr_b16 a[20:21], v15 offset:4640
    ds_read_b64_tr_b16 a[22:23], v15 offset:5792
    ds_read_b128 a[44:47], v12
    v_mfma_f32_32x32x16_bf16 v[128:143], a[28:31], a[52:55], v[128:143]
    ds_read_b64_tr_b16 a[24:25], v15 offset:4672
    ds_read_b64_tr_b16 a[26:27], v15 offset:5824
    s_add_u32 m0, s60, s57
    s_nop 0
    buffer_load_dwordx4 v6, s[8:11], s55 offen lds
    s_branch L_f4loop
L_f4exit:
    s_barrier
    s_cmp_lt_u32 s48, 6
    s_cbranch_scc1 L_f4h
    v_mfma_f32_32x32x16_bf16 v[128:143], a[12:15], a[48:51], v[128:143]
    ds_read_b64_tr_b16 a[0:1], v15 offset:0
    ds_read_b64_tr_b16 a[2:3], v15 offset:1152
    ds_read_b64_tr_b16 a[4:5], v15 offset:32
    ds_read_b64_tr_b16 a[6:7], v15 offset:1184
    ds_read_b128 a[40:43], v11
    v_readfirstlane_b32 s68, v24
    s_mov_b32 s69, 0
L_tagf4:
    s_nop 2
    s_cmp_lg_u32 s68, 0
    s_cbranch_scc1 L_tagokf4
    v_mov_b32 v1, 0
    global_load_dword v24, v1, s[28:29] sc1
    s_waitcnt vmcnt(0)
    v_readfirstlane_b32 s68, v24
    s_add_u32 s69, s69, 1
    s_cmp_lt_u32 s69, 262144
    s_cbranch_scc1 L_tagf4
L_tagokf4:
    s_mov_b32 s54, s32
    s_mov_b32 s56, s33
    buffer_load_dword v24, v22, s[80:83], 0 offen sc1
    s_add_u32 m0, s60, s56
    s_nop 0
    buffer_load_dwordx4 v25, s[16:19], s54 offen lds
    v_mfma_f32_32x32x16_bf16 v[80:95], a[16:19], a[52:55], v[80:95]
    ds_read_b64_tr_b16 a[8:9], v15 offset:64
    ds_read_b64_tr_b16 a[10:11], v15 offset:1216
    ds_read_b64_tr_b16 a[12:13], v15 offset:96
    ds_read_b64_tr_b16 a[14:15], v15 offset:1248
    v_mfma_f32_32x32x16_bf16 v[96:111], a[20:23], a[52:55], v[96:111]
    ds_read_b64_tr_b16 a[16:17], v15 offset:4608
    ds_read_b64_tr_b16 a[18:19], v15 offset:5760
    buffer_load_dwordx4 v26, s[16:19], s54 offen offset:1024 lds
    v_mfma_f32_32x32x16_bf16 v[112:127], a[24:27], a[52:55], v[112:127]
    ds_read_b64_tr_b16 a[20:21], v15 offset:4640
    ds_read_b64_tr_b16 a[22:23], v15 offset:5792
    ds_read_b128 a[44:47], v12
    v_mfma_f32_32x32x16_bf16 v[128:143], a[28:31], a[52:55], v[128:143]
    ds_read_b64_tr_b16 a[24:25], v15 offset:4672
    ds_read_b64_tr_b16 a[26:27], v15 offset:5824
    buffer_load_dwordx4 v27, s[16:19], s54 offen offset:2048 lds
L_f4tail:
    s_waitcnt lgkmcnt(11)
    v_mfma_f32_32x32x16_bf16 v[80:95], a[0:3], a[40:43], v[80:95]
    ds_read_b64_tr_b16 a[28:29], v15 offset:4704
    ds_read_b64_tr_b16 a[30:31], v15 offset:5856
    s_cmp_eq_u32 s60, s77
    s_cselect_b32 s61, s37, s77
    v_mfma_f32_32x32x16_bf16 v[96:111], a[4:7], a[40:43], v[96:111]
    ds_read_b64_tr_b16 a[0:1], v15 offset:9216
    ds_read_b64_tr_b16 a[2:3], v15 offset:10368
    v_add_u32 v11, s61, v11
    s_waitcnt lgkmcnt(11)
    v_mfma_f32_32x32x16_bf16 v[112:127], a[8:11], a[40:43], v[112:127]
    ds_read_b64_tr_b16 a[4:5], v15 offset:9248
    ds_read_b64_tr_b16 a[6:7], v15 offset:10400
    ds_read_b128 a[48:51], v13
    buffer_load_dwordx4 v28, s[16:19], s54 offen offset:3072 lds
    v_add_u32 v12, s61, v12
    v_mfma_f32_32x32x16_bf16 v[128:143], a[12:15], a[40:43], v[128:143]
    ds_read_b64_tr_b16 a[8:9], v15 offset:9280
    ds_read_b64_tr_b16 a[10:11], v15 offset:10432
    s_waitcnt lgkmcnt(11)
    v_mfma_f32_32x32x16_bf16 v[80:95], a[16:19], a[44:47], v[80:95]
    ds_read_b64_tr_b16 a[12:13], v15 offset:9312
    ds_read_b64_tr_b16 a[14:15], v15 offset:10464
    s_add_u32 m0, m0, 4096
    s_add_u32 s54, s54, 32768
    buffer_load_dwordx4 v25, s[16:19], s54 offen lds
    v_add_u32 v13, s61, v13
    v_mfma_f32_32x32x16_bf16 v[96:111], a[20:23], a[44:47], v[96:111]
    ds_read_b64_tr_b16 a[16:17], v15 offset:13824
    ds_read_b64_tr_b16 a[18:19], v15 offset:14976
    ds_read_b128 a[52:55], v14
    s_waitcnt lgkmcnt(12)
    v_mfma_f32_32x32x16_bf16 v[112:127], a[24:27], a[44:47], v[112:127]
    ds_read_b64_tr_b16 a[20:21], v15 offset:13856
    ds_read_b64_tr_b16 a[22:23], v15 offset:15008
    buffer_load_dwordx4 v26, s[16:19], s54 offen offset:1024 lds
    s_add_u32 s54, s54, 65536
    v_mfma_f32_32x32x16_bf16 v[128:143], a[28:31], a[44:47], v[128:143]
    ds_read_b64_tr_b16 a[24:25], v15 offset:13888
    ds_read_b64_tr_b16 a[26:27], v15 offset:15040
    s_waitcnt lgkmcnt(11)
    v_mfma_f32_32x32x16_bf16 v[80:95], a[0:3], a[48:51], v[80:95]
    ds_read_b64_tr_b16 a[28:29], v15 offset:13920
    ds_read_b64_tr_b16 a[30:31], v15 offset:15072
    s_cmp_eq_u32 s60, 107008
    s_cselect_b32 s72, s37, s77
    s_add_u32 s60, s60, s72
    v_add_u32 v14, s61, v14
    v_add_u32 v15, s61, v15
    v_mfma_f32_32x32x16_bf16 v[96:111], a[4:7], a[48:51], v[96:111]
    s_add_u32 s48, s48, 1
    s_cmp_lt_u32 s48, 8
    s_waitcnt vmcnt(6) lgkmcnt(0)
    v_mfma_f32_32x32x16_bf16 v[112:127], a[8:11], a[48:51], v[112:127]
    s_cbranch_scc0 L_f4texit
    s_barrier
    v_mfma_f32_32x32x16_bf16 v[128:143], a[12:15], a[48:51], v[128:143]
    ds_read_b64_tr_b16 a[0:1], v15 offset:0
    ds_read_b64_tr_b16 a[2:3], v15 offset:1152
    ds_read_b64_tr_b16 a[4:5], v15 offset:32
    ds_read_b64_tr_b16 a[6:7], v15 offset:1184
    ds_read_b128 a[40:43], v11
    s_mov_b32 s69, 0
L_f0f4:
    v_cmp_ne_u32 vcc, s68, v24
    s_nop 3
    s_cbranch_vccz L_f0okf4
    buffer_load_dword v24, v22, s[80:83], 0 offen sc1
    s_waitcnt vmcnt(0)
    s_add_u32 s69, s69, 1
    s_cmp_lt_u32 s69, 262144
    s_cbranch_scc1 L_f0f4
L_f0okf4:
    buffer_load_dword v16, v20, s[80:83], 0 offen sc1
    s_mov_b32 m0, s35
    buffer_load_dwordx4 v[40:43], v21, s[80:83], s34 offen sc1
    buffer_load_dwordx4 v29, s[80:83], s38 offen sc1 lds
    s_add_u32 m0, s60, s56
    s_nop 0
    buffer_load_dwordx4 v25, s[16:19], s54 offen lds
    v_mfma_f32_32x32x16_bf16 v[80:95], a[16:19], a[52:55], v[80:95]
    ds_read_b64_tr_b16 a[8:9], v15 offset:64
    ds_read_b64_tr_b16 a[10:11], v15 offset:1216
    ds_read_b64_tr_b16 a[12:13], v15 offset:96
    ds_read_b64_tr_b16 a[14:15], v15 offset:1248
    v_mfma_f32_32x32x16_bf16 v[96:111], a[20:23], a[52:55], v[96:111]
    ds_read_b64_tr_b16 a[16:17], v15 offset:4608
    ds_read_b64_tr_b16 a[18:19], v15 offset:5760
    buffer_load_dwordx4 v26, s[16:19], s54 offen offset:1024 lds
    v_mfma_f32_32x32x16_bf16 v[112:127], a[24:27], a[52:55], v[112:127]
    ds_read_b64_tr_b16 a[20:21], v15 offset:4640
    ds_read_b64_tr_b16 a[22:23], v15 offset:5792
    ds_read_b128 a[44:47], v12
    v_mfma_f32_32x32x16_bf16 v[128:143], a[28:31], a[52:55], v[128:143]
    ds_read_b64_tr_b16 a[24:25], v15 offset:4672
    ds_read_b64_tr_b16 a[26:27], v15 offset:5824
    buffer_load_dwordx4 v27, s[16:19], s54 offen offset:2048 lds
    s_branch L_f4tail
L_f4texit:
    s_barrier
    ds_read_b128 v[44:47], v30 offset:0
    ds_read_b128 v[48:51], v30 offset:1024
    ds_read_b128 v[32:35], v30 offset:2048
    v_mfma_f32_32x32x16_bf16 v[128:143], a[12:15], a[48:51], v[128:143]
    v_and_b32 v1, 0xffff, v16
    v_and_b32 v16, 0xffff0000, v16
    v_lshl_or_b32 v36, v1, 16, v1
    v_rcp_f32 v18, v16
    v_mov_b32 v37, v36
    v_mfma_f32_32x32x16_bf16 v[80:95], a[16:19], a[52:55], v[80:95]
    v_mov_b32 v38, v36
    v_mov_b32 v39, v36
    v_mul_f32 v20, v16, v16
    v_mul_f32 v22, v16, v16
    v_mul_f32 v18, 3216550459, v18
    v_mov_b32 v10, v31
    v_add_u32 v4, s1, v31
    v_add_u32 v6, 107008, v4
    v_xor_b32 v7, 64, v6
    v_add_u32 v11, 14336, v25
    s_mov_b32 s74, 1
    s_waitcnt lgkmcnt(0)
    v_mfma_f32_32x32x16_bf16 v[80:95], v[44:47], v[36:39], v[80:95]
    v_mfma_f32_32x32x16_bf16 v[96:111], a[20:23], a[52:55], v[96:111]
    s_add_u32 m0, s40, 53504
    s_nop 0
    buffer_load_dwordx4 v25, s[16:19], s43 offen lds
    v_mfma_f32_32x32x16_bf16 v[96:111], v[48:51], v[36:39], v[96:111]
    buffer_load_dwordx4 v11, s[16:19], s43 offen offset:2048 lds
    s_nop 5
    v_mul_f32 v52, v18, v80
    v_mul_f32 v53, v18, v81
    v_mul_f32 v54, v18, v82
    v_mul_f32 v55, v18, v83
    v_mul_f32 v56, v18, v84
    v_mul_f32 v57, v18, v85
    v_mul_f32 v58, v18, v86
    v_mul_f32 v59, v18, v87
    v_exp_f32 v52, v52
    v_exp_f32 v53, v53
    v_exp_f32 v54, v54
    v_mfma_f32_32x32x16_bf16 v[112:127], a[24:27], a[52:55], v[112:127]
    s_add_u32 s43, s43, 32768
    s_add_u32 m0, s40, 57600
    s_nop 0
    buffer_load_dwordx4 v25, s[16:19], s43 offen lds
    v_exp_f32 v55, v55
    v_exp_f32 v56, v56
    v_exp_f32 v57, v57
    v_exp_f32 v58, v58
    v_exp_f32 v59, v59
    v_mul_f32 v60, v80, v88
    v_mul_f32 v61, v81, v89
    v_mul_f32 v62, v82, v90
    v_mul_f32 v63, v83, v91
    v_mul_f32 v64, v84, v92
    v_mul_f32 v65, v85, v93
    v_mfma_f32_32x32x16_bf16 v[112:127], v[32:35], v[36:39], v[112:127]
    buffer_load_dwordx4 v11, s[16:19], s43 offen offset:2048 lds
    v_mul_f32 v66, v86, v94
    v_mul_f32 v67, v87, v95
    v_fma_f32 v52, v52, v20, v20
    v_fma_f32 v53, v53, v20, v20
    v_fma_f32 v54, v54, v20, v20
    v_fma_f32 v55, v55, v20, v20
    v_fma_f32 v56, v56, v20, v20
    v_fma_f32 v57, v57, v20, v20
    v_fma_f32 v58, v58, v20, v20
    v_fma_f32 v59, v59, v20, v20
    v_rcp_f32 v52, v52
    v_mfma_f32_32x32x16_bf16 v[128:143], a[28:31], a[52:55], v[128:143]
    s_add_u32 s43, s43, 32768
    s_add_u32 m0, s40, 61696
    s_nop 0
    buffer_load_dwordx4 v25, s[16:19], s43 offen lds
    v_rcp_f32 v53, v53
    v_rcp_f32 v54, v54
    v_rcp_f32 v55, v55
    v_rcp_f32 v56, v56
    v_rcp_f32 v57, v57
    v_rcp_f32 v58, v58
    v_rcp_f32 v59, v59
    v_mul_f32 v52, v52, v60
    v_mul_f32 v53, v53, v61
    v_mul_f32 v54, v54, v62
    v_mul_f32 v55, v55, v63
    v_mfma_f32_32x32x16_bf16 v[128:143], v[40:43], v[36:39], v[128:143]
    buffer_load_dwordx4 v11, s[16:19], s43 offen offset:2048 lds
    v_mul_f32 v56, v56, v64
    v_mul_f32 v57, v57, v65
    v_mul_f32 v58, v58, v66
    v_mul_f32 v59, v59, v67
    v_cvt_pk_bf16_f32 v68, v52, v53
    v_cvt_pk_bf16_f32 v69, v54, v55
    v_cvt_pk_bf16_f32 v70, v56, v57
    v_cvt_pk_bf16_f32 v71, v58, v59
    buffer_store_dwordx4 v[68:71], v29, s[12:15], s39 offen sc1
    v_pk_mul_f32 v[52:53], v[96:97], v[18:19] op_sel_hi:[1,0]
    v_pk_mul_f32 v[54:55], v[98:99], v[18:19] op_sel_hi:[1,0]
    v_pk_mul_f32 v[56:57], v[100:101], v[18:19] op_sel_hi:[1,0]
    v_pk_mul_f32 v[58:59], v[102:103], v[18:19] op_sel_hi:[1,0]
    v_exp_f32 v52, v52
    v_exp_f32 v53, v53
    v_exp_f32 v54, v54
    v_exp_f32 v55, v55
    v_exp_f32 v56, v56
    v_exp_f32 v57, v57
    v_exp_f32 v58, v58
    v_exp_f32 v59, v59
    v_pk_mul_f32 v[60:61], v[96:97], v[104:105]
    v_pk_mul_f32 v[62:63], v[98:99], v[106:107]
    v_pk_mul_f32 v[64:65], v[100:101], v[108:109]
    v_pk_mul_f32 v[66:67], v[102:103], v[110:111]
    v_pk_fma_f32 v[52:53], v[52:53], v[20:21], v[22:23] op_sel_hi:[1,0,0]
    v_pk_fma_f32 v[54:55], v[54:55], v[20:21], v[22:23] op_sel_hi:[1,0,0]
    v_pk_fma_f32 v[56:57], v[56:57], v[20:21], v[22:23] op_sel_hi:[1,0,0]
    v_pk_fma_f32 v[58:59], v[58:59], v[20:21], v[22:23] op_sel_hi:[1,0,0]
    v_rcp_f32 v52, v52
    v_rcp_f32 v53, v53
    v_rcp_f32 v54, v54
    v_rcp_f32 v55, v55
    v_rcp_f32 v56, v56
    v_rcp_f32 v57, v57
    v_rcp_f32 v58, v58
    v_rcp_f32 v59, v59
    v_pk_mul_f32 v[52:53], v[52:53], v[60:61]
    v_pk_mul_f32 v[54:55], v[54:55], v[62:63]
    v_pk_mul_f32 v[56:57], v[56:57], v[64:65]
    v_pk_mul_f32 v[58:59], v[58:59], v[66:67]
    v_cvt_pk_bf16_f32 v72, v52, v53
    v_cvt_pk_bf16_f32 v73, v54, v55
    v_cvt_pk_bf16_f32 v74, v56, v57
    v_cvt_pk_bf16_f32 v75, v58, v59
    buffer_store_dwordx4 v[72:75], v29, s[12:15], s39 offen offset:1024 sc1
    v_pk_mul_f32 v[52:53], v[112:113], v[18:19] op_sel_hi:[1,0]
    v_pk_mul_f32 v[54:55], v[114:115], v[18:19] op_sel_hi:[1,0]
    v_pk_mul_f32 v[56:57], v[116:117], v[18:19] op_sel_hi:[1,0]
    v_pk_mul_f32 v[58:59], v[118:119], v[18:19] op_sel_hi:[1,0]
    v_exp_f32 v52, v52
    v_exp_f32 v53, v53
    v_exp_f32 v54, v54
    v_exp_f32 v55, v55
    v_exp_f32 v56, v56
    v_exp_f32 v57, v57
    v_exp_f32 v58, v58
    v_exp_f32 v59, v59
    v_pk_mul_f32 v[60:61], v[112:113], v[120:121]
    v_pk_mul_f32 v[62:63], v[114:115], v[122:123]
    v_pk_mul_f32 v[64:65], v[116:117], v[124:125]
    v_pk_mul_f32 v[66:67], v[118:119], v[126:127]
    v_pk_fma_f32 v[52:53], v[52:53], v[20:21], v[22:23] op_sel_hi:[1,0,0]
    v_pk_fma_f32 v[54:55], v[54:55], v[20:21], v[22:23] op_sel_hi:[1,0,0]
    v_pk_fma_f32 v[56:57], v[56:57], v[20:21], v[22:23] op_sel_hi:[1,0,0]
    v_pk_fma_f32 v[58:59], v[58:59], v[20:21], v[22:23] op_sel_hi:[1,0,0]
    v_rcp_f32 v52, v52
    v_rcp_f32 v53, v53
    v_rcp_f32 v54, v54
    v_rcp_f32 v55, v55
    v_rcp_f32 v56, v56
    v_rcp_f32 v57, v57
    v_rcp_f32 v58, v58
    v_rcp_f32 v59, v59
    v_pk_mul_f32 v[52:53], v[52:53], v[60:61]
    v_pk_mul_f32 v[54:55], v[54:55], v[62:63]
    v_pk_mul_f32 v[56:57], v[56:57], v[64:65]
    v_pk_mul_f32 v[58:59], v[58:59], v[66:67]
    v_cvt_pk_bf16_f32 v68, v52, v53
    v_cvt_pk_bf16_f32 v69, v54, v55
    v_cvt_pk_bf16_f32 v70, v56, v57
    v_cvt_pk_bf16_f32 v71, v58, v59
    buffer_store_dwordx4 v[68:71], v29, s[12:15], s39 offen offset:2048 sc1
    v_pk_mul_f32 v[52:53], v[128:129], v[18:19] op_sel_hi:[1,0]
    v_pk_mul_f32 v[54:55], v[130:131], v[18:19] op_sel_hi:[1,0]
    v_pk_mul_f32 v[56:57], v[132:133], v[18:19] op_sel_hi:[1,0]
    v_pk_mul_f32 v[58:59], v[134:135], v[18:19] op_sel_hi:[1,0]
    v_exp_f32 v52, v52
    v_exp_f32 v53, v53
    v_exp_f32 v54, v54
    v_exp_f32 v55, v55
    v_exp_f32 v56, v56
    v_exp_f32 v57, v57
    v_exp_f32 v58, v58
    v_exp_f32 v59, v59
    v_pk_mul_f32 v[60:61], v[128:129], v[136:137]
    v_pk_mul_f32 v[62:63], v[130:131], v[138:139]
    v_pk_mul_f32 v[64:65], v[132:133], v[140:141]
    v_pk_mul_f32 v[66:67], v[134:135], v[142:143]
    v_pk_fma_f32 v[52:53], v[52:53], v[20:21], v[22:23] op_sel_hi:[1,0,0]
    v_pk_fma_f32 v[54:55], v[54:55], v[20:21], v[22:23] op_sel_hi:[1,0,0]
    v_pk_fma_f32 v[56:57], v[56:57], v[20:21], v[22:23] op_sel_hi:[1,0,0]
    v_pk_fma_f32 v[58:59], v[58:59], v[20:21], v[22:23] op_sel_hi:[1,0,0]
    v_rcp_f32 v52, v52
    v_rcp_f32 v53, v53
    v_rcp_f32 v54, v54
    v_rcp_f32 v55, v55
    v_rcp_f32 v56, v56
    v_rcp_f32 v57, v57
    v_rcp_f32 v58, v58
    v_rcp_f32 v59, v59
    v_pk_mul_f32 v[52:53], v[52:53], v[60:61]
    v_pk_mul_f32 v[54:55], v[54:55], v[62:63]
    v_pk_mul_f32 v[56:57], v[56:57], v[64:65]
    v_pk_mul_f32 v[58:59], v[58:59], v[66:67]
    v_cvt_pk_bf16_f32 v72, v52, v53
    v_cvt_pk_bf16_f32 v73, v54, v55
    v_cvt_pk_bf16_f32 v74, v56, v57
    v_cvt_pk_bf16_f32 v75, v58, v59
    buffer_store_dwordx4 v[72:75], v29, s[12:15], s39 offen offset:3072 sc1
    ds_read_b64_tr_b16 a[0:1], v6 offset:0
    ds_read_b64_tr_b16 a[2:3], v6 offset:1024
    ds_read_b64_tr_b16 a[4:5], v7 offset:0
    ds_read_b64_tr_b16 a[6:7], v7 offset:1024
    ds_read_b64_tr_b16 a[8:9], v6 offset:2048
    ds_read_b64_tr_b16 a[10:11], v6 offset:3072
    ds_read_b64_tr_b16 a[12:13], v7 offset:2048
    ds_read_b64_tr_b16 a[14:15], v7 offset:3072
    ds_read_b64_tr_b16 a[16:17], v6 offset:4096
    ds_read_b64_tr_b16 a[18:19], v6 offset:5120
    ds_read_b64_tr_b16 a[20:21], v7 offset:4096
    ds_read_b64_tr_b16 a[22:23], v7 offset:5120
    ds_read_b64_tr_b16 a[24:25], v6 offset:6144
    ds_read_b64_tr_b16 a[26:27], v6 offset:7168
    ds_read_b64_tr_b16 a[28:29], v7 offset:6144
    ds_read_b64_tr_b16 a[30:31], v7 offset:7168
    ds_read_b64_tr_b16 a[32:33], v6 offset:8192
    ds_read_b64_tr_b16 a[34:35], v6 offset:9216
    ds_read_b64_tr_b16 a[36:37], v7 offset:8192
    ds_read_b64_tr_b16 a[38:39], v7 offset:9216
    ds_read_b64_tr_b16 a[40:41], v6 offset:10240
    ds_read_b64_tr_b16 a[42:43], v6 offset:11264
    ds_read_b64_tr_b16 a[44:45], v7 offset:10240
    ds_read_b64_tr_b16 a[46:47], v7 offset:11264
    s_waitcnt vmcnt(10) lgkmcnt(0)
    s_barrier
    s_branch L_phase2
L_f4h:
    s_bitset0_b32 s0, s48
    s_ff1_i32_b32 s63, s0
    s_cmp_lg_u32 s48, s49
    s_cbranch_scc1 L_f4h0
    s_sub_u32 s54, s54, 1024
    s_lshl_b32 s69, s53, 3
    s_sub_u32 s55, s55, s69
L_f4h0:
    s_cmp_lt_u32 s48, 3
    s_cbranch_scc1 L_f4h1
    buffer_load_dword v19, v18, s[84:87], s46 offen
L_f4h1:
    s_lshl_b32 s69, s3, 3
    s_add_u32 s69, s69, s48
    s_cmp_lg_u32 s69, 1
    s_cbranch_scc1 L_f4back
    v_readfirstlane_b32 s68, v24
    s_mov_b32 s69, 0
L_tagf4h:
    s_nop 2
    s_cmp_lg_u32 s68, 0
    s_cbranch_scc1 L_tagokf4h
    v_mov_b32 v1, 0
    global_load_dword v24, v1, s[28:29] sc1
    s_waitcnt vmcnt(0)
    v_readfirstlane_b32 s68, v24
    s_add_u32 s69, s69, 1
    s_cmp_lt_u32 s69, 262144
    s_cbranch_scc1 L_tagf4h
L_tagokf4h:
    v_mov_b32 v1, s68
    s_mov_b64 exec, 3
    buffer_store_dword v1, v23, s[80:83], 0 offen sc1
    s_mov_b64 exec, -1
    s_branch L_f4back
L_attn:
    s_sub_u32 s70, s70, 20
    s_lshr_b32 s66, s70, 2
    s_lshr_b32 s49, s66, 1
    s_lshl_b32 s78, s71, 1
    s_add_u32 s49, s49, s78
    s_and_b32 s49, s49, 7
    s_mul_i32 s71, s71, 3
    s_add_u32 s66, s66, s71
    s_and_b32 s67, s70, 3
    s_lshl_b32 s72, s72, 2
    s_add_u32 s67, s67, s72
    s_and_b32 s69, s3, 1
    s_lshl_b32 s70, s69, 6
    v_xor_b32 v4, s70, v4
    v_xor_b32 v5, 64, v4
    v_add_u32 v5, 15360, v5
    v_add_u32 v6, 30720, v4
    v_and_b32 v1, 1, v32
    s_lshl_b32 s70, s69, 1
    v_add_u32 v1, s70, v1
    v_lshlrev_b32 v1, 1, v1
    v_xor_b32 v1, v31, v1
    v_lshlrev_b32 v1, 4, v1
    v_mul_u32_u24 v2, 3072, v30
    s_mul_i32 s70, s3, 24576
    v_add3_u32 v7, v1, v2, s70
    s_mul_i32 s74, s66, 176
    s_and_b32 s70, s3, 3
    s_mul_i32 s71, s70, 48
    s_lshr_b32 s72, s3, 2
    s_add_u32 s50, s74, s71
    s_add_u32 s50, s50, s72
    s_lshl_b32 s50, s50, 10
    s_lshl_b32 s51, s67, 7
    s_mov_b32 s53, 196608
    s_mul_i32 s56, s3, 3072
    s_add_u32 s57, s56, 24576
    s_mov_b64 s[88:89], -1
    s_cmp_eq_u32 s70, 0
    s_cmov_b32 s88, 0xffffff00
    s_or_b32 s70, s70, s66
    s_cmp_eq_u32 s70, 0
    s_cselect_b32 s70, 2147483648, 0
    v_add_u32 v4, s70, v4
    s_lshl_b32 s54, s49, 7
    s_add_u32 s54, s54, s50
    s_mul_i32 s55, s49, s53
    s_add_u32 s55, s55, s51
    s_add_u32 s49, s49, 1
    s_and_b32 s49, s49, 7
    s_waitcnt lgkmcnt(0)
    s_mov_b32 s20, s32
    s_mov_b32 s21, s33
    s_mov_b32 s22, 2097152
    s_mov_b32 s23, 0x20000
    s_lshl_b32 s69, s2, 13
    s_lshl_b32 s70, s3, 10
    s_add_u32 s69, s69, s70
    buffer_load_dwordx4 v[48:51], v29, s[20:23], s69 offen
    s_mov_b32 s8, s34
    s_mov_b32 s9, s35
    s_mov_b32 s10, 1572864
    s_mov_b32 s11, 0x20000
    s_sub_u32 s4, s32, 16384
    s_subb_u32 s5, s33, 0
    s_mov_b32 s6, 2113536
    s_mov_b32 s7, 0x20000
    s_add_u32 m0, s60, s56
    s_mov_b64 exec, s[88:89]
    buffer_load_dwordx4 v4, s[4:7], s54 offen lds
    s_mov_b64 exec, -1
    buffer_load_dwordx4 v5, s[4:7], s54 offen offset:1024 lds
    buffer_load_dwordx4 v6, s[4:7], s54 offen offset:2048 lds
    s_add_u32 m0, s60, s57
    s_nop 0
    buffer_load_dwordx4 v7, s[8:11], s55 offen lds
    buffer_load_dwordx4 v7, s[8:11], s55 offen offset:1024 lds
    buffer_load_dwordx4 v7, s[8:11], s55 offen offset:2048 lds
    s_add_u32 s60, s60, 53504
    s_cmp_eq_u32 s60, 160512
    s_cselect_b32 s60, 0, s60
    s_lshl_b32 s54, s49, 7
    s_add_u32 s54, s54, s50
    s_mul_i32 s55, s49, s53
    s_add_u32 s55, s55, s51
    s_add_u32 s49, s49, 1
    s_and_b32 s49, s49, 7
    s_lshr_b32 s70, s2, 3
    s_mov_b32 s78, 1219594272
    s_mov_b32 s79, 77820721
    s_cmp_ge_u32 s70, 12
    s_cmov_b32 s78, 3705027818
    s_cmov_b32 s79, 172634365
    s_cselect_b32 s71, 12, 0
    s_cmp_ge_u32 s70, 24
    s_cmov_b32 s78, 2041373397
    s_cmov_b32 s79, 247
    s_cmov_b32 s71, 24
    s_sub_u32 s70, s70, s71
    s_mul_i32 s70, s70, 5
    s_lshr_b64 s[78:79], s[78:79], s70
    s_and_b32 s65, s78, 7
    s_bfe_u32 s64, s78, 0x20003
    s_and_b32 s70, s2, 7
    s_lshl_b32 s70, s70, 2
    s_add_u32 s64, s64, s70
    s_mov_b32 s80, s30
    s_mov_b32 s81, s31
    s_mov_b32 s82, 124928
    s_mov_b32 s83, 0x20000
    s_mov_b32 s24, s46
    s_mov_b32 s25, s47
    s_mov_b32 s26, 2097152
    s_mov_b32 s27, 0x20000
    s_add_u32 s12, s30, 1048576
    s_addc_u32 s13, s31, 0
    s_mov_b32 s14, 7733248
    s_mov_b32 s15, 0x20000
    s_lshr_b32 s52, s3, 1
    s_lshr_b32 s69, s3, 2
    s_xor_b32 s52, s52, s69
    s_and_b32 s73, s3, 1
    s_cmp_eq_u32 s52, 0
    s_cselect_b32 s16, s36, s44
    s_cselect_b32 s17, s37, s45
    s_mov_b32 s18, 1409024
    s_cmov_b32 s18, 524288
    s_mov_b32 s19, 0x20000
    s_mov_b32 s48, 0
    s_cmp_eq_u32 s3, 0
    s_cselect_b32 s0, 2, 0
    s_lshr_b32 s69, s3, 2
    s_add_u32 s69, s69, 3
    s_bitset1_b32 s0, s69
    v_lshrrev_b32 v1, 3, v0
    v_and_b32 v2, 7, v0
    v_bfe_u32 v3, v0, 4, 1
    v_lshlrev_b32 v3, 2, v3
    v_xor_b32 v2, v2, v3
    v_lshlrev_b32 v2, 4, v2
    v_lshl_add_u32 v25, v1, 10, v2
    v_add_u32 v26, 7168, v25
    v_add_u32 v27, 14336, v25
    v_add_u32 v28, 21504, v25
    s_sub_u32 s69, s52, 1
    s_max_i32 s69, s69, 0
    s_mul_i32 s76, s69, 475136
    s_lshl_b32 s69, s65, 7
    s_add_u32 s76, s76, s69
    v_mov_b32 v56, 0
    v_mov_b32 v57, 0
    v_mov_b32 v58, 0
    v_mov_b32 v59, 0
    s_nop 1
    v_mfma_f32_32x32x16_bf16 v[80:95], v[56:59], v[56:59], 0
    v_mfma_f32_32x32x16_bf16 v[96:111], v[56:59], v[56:59], 0
    v_mfma_f32_32x32x16_bf16 v[112:127], v[56:59], v[56:59], 0
    v_mfma_f32_32x32x16_bf16 v[128:143], v[56:59], v[56:59], 0
    v_mfma_f32_32x32x16_bf16 v[144:159], v[56:59], v[56:59], 0
    v_min_u32 v1, 5, v30
    v_lshrrev_b32 v2, 1, v1
    v_mul_u32_u24 v2, 53504, v2
    v_and_b32 v1, 1, v1
    v_mul_u32_u24 v1, 12288, v1
    v_add_u32 v1, v1, v2
    v_lshl_add_u32 v1, v31, 4, v1
    v_mov_b32 v60, s62
    v_mov_b32 v61, s62
    v_mov_b32 v62, s62
    v_mov_b32 v63, s62
    ds_write_b128 v1, v[60:63]
    v_and_b32 v33, 15, v0
    s_mul_i32 s69, s73, 96
    v_add_u32 v1, s69, v33
    v_bfe_u32 v2, v1, 1, 3
    v_xor_b32 v2, v2, v32
    v_lshlrev_b32 v2, 4, v2
    v_lshl_add_u32 v11, v1, 7, v2
    v_xor_b32 v12, 64, v11
    v_mul_u32_u24 v1, 3072, v32
    v_bfe_u32 v2, v0, 2, 2
    v_lshl_add_u32 v1, v2, 7, v1
    v_bfe_u32 v2, v0, 3, 2
    s_lshr_b32 s69, s3, 1
    v_xor_b32 v2, s69, v2
    v_lshl_add_u32 v1, v2, 5, v1
    v_and_b32 v2, 3, v0
    v_lshl_add_u32 v1, v2, 3, v1
    v_add_u32 v15, 24576, v1
    s_lshl_b32 s69, s2, 2
    s_add_u32 s69, s69, 11264
    v_mov_b32 v23, s69
    s_lshr_b32 s69, s74, 3
    s_sub_u32 s69, s69, 2
    v_min_u32 v1, 23, v0
    v_add_u32 v1, s69, v1
    v_max_i32 v1, 0, v1
    v_min_u32 v1, 255, v1
    v_lshlrev_b32 v1, 2, v1
    v_add_u32 v22, 11264, v1
    v_lshlrev_b32 v2, 2, v32
    v_sub_u32 v2, v33, v2
    v_mov_b32 v3, 0xff800000
    v_add_u32 v36, 16, v2
    v_subrev_u32 v40, 0, v2
    v_cmp_gt_u32 vcc, 8, v36
    v_cmp_gt_u32 s[78:79], 8, v40
    s_nop 0
    v_cndmask_b32 v36, v3, 0, vcc
    v_cndmask_b32 v40, v3, 0, s[78:79]
    v_add_u32 v37, 15, v2
    v_subrev_u32 v41, 1, v2
    v_cmp_gt_u32 vcc, 8, v37
    v_cmp_gt_u32 s[78:79], 8, v41
    s_nop 0
    v_cndmask_b32 v37, v3, 0, vcc
    v_cndmask_b32 v41, v3, 0, s[78:79]
    v_add_u32 v38, 14, v2
    v_subrev_u32 v42, 2, v2
    v_cmp_gt_u32 vcc, 8, v38
    v_cmp_gt_u32 s[78:79], 8, v42
    s_nop 0
    v_cndmask_b32 v38, v3, 0, vcc
    v_cndmask_b32 v42, v3, 0, s[78:79]
    v_add_u32 v39, 13, v2
    v_subrev_u32 v43, 3, v2
    v_cmp_gt_u32 vcc, 8, v39
    v_cmp_gt_u32 s[78:79], 8, v43
    s_nop 0
    v_cndmask_b32 v39, v3, 0, vcc
    v_cndmask_b32 v43, v3, 0, s[78:79]
    s_cmp_eq_u32 s66, 0
    s_cselect_b32 s69, 32, 0
    v_cmp_gt_u32 vcc, s69, v0
    s_nop 1
    v_cndmask_b32 v44, v40, v3, vcc
    v_cndmask_b32 v45, v41, v3, vcc
    v_cndmask_b32 v46, v42, v3, vcc
    v_cndmask_b32 v47, v43, v3, vcc
    v_lshlrev_b32 v1, 1, v33
    s_add_u32 s69, s73, s74
    s_sub_u32 s69, s69, 16
    v_add_u32 v1, s69, v1
    v_mov_b32 v3, 2147483648
    v_cmp_gt_u32 vcc, 2048, v1
    v_lshlrev_b32 v2, 2, v1
    v_add_u32 v2, 16384, v2
    v_cndmask_b32 v30, v3, v2, vcc
    v_add_u32 v1, 32, v1
    v_cmp_gt_u32 vcc, 2048, v1
    v_lshlrev_b32 v2, 2, v1
    v_add_u32 v2, 16384, v2
    v_cndmask_b32 v31, v3, v2, vcc
    v_add_u32 v1, 32, v1
    v_cmp_gt_u32 vcc, 2048, v1
    v_lshlrev_b32 v2, 2, v1
    v_add_u32 v2, 16384, v2
    v_cndmask_b32 v32, v3, v2, vcc
    v_add_u32 v1, 32, v1
    v_cmp_gt_u32 vcc, 2048, v1
    v_lshlrev_b32 v2, 2, v1
    v_add_u32 v2, 16384, v2
    v_cndmask_b32 v33, v3, v2, vcc
    v_add_u32 v1, 32, v1
    v_cmp_gt_u32 vcc, 2048, v1
    v_lshlrev_b32 v2, 2, v1
    v_add_u32 v2, 16384, v2
    v_cndmask_b32 v34, v3, v2, vcc
    v_add_u32 v1, 32, v1
    v_cmp_gt_u32 vcc, 2048, v1
    v_lshlrev_b32 v2, 2, v1
    v_add_u32 v2, 16384, v2
    v_cndmask_b32 v35, v3, v2, vcc
    s_mul_i32 s69, s73, 49152
    s_add_u32 s32, s76, s69
    s_mul_i32 s33, s52, 12288
    s_mul_i32 s69, s73, 6144
    s_add_u32 s33, s33, s69
    v_lshrrev_b32 v1, 5, v0
    v_bfe_u32 v2, v0, 2, 2
    v_lshl_add_u32 v1, v1, 2, v2
    v_lshlrev_b32 v1, 7, v1
    v_bfe_u32 v2, v0, 3, 1
    v_lshl_add_u32 v1, v2, 6, v1
    v_bfe_u32 v2, v0, 4, 1
    v_lshl_add_u32 v1, v2, 5, v1
    v_and_b32 v2, 3, v0
    v_lshl_add_u32 v10, v2, 3, v1
    s_mul_i32 s1, s52, 12288
    s_lshl_b32 s69, s73, 10
    s_add_u32 s40, s1, s69
    s_min_u32 s70, s52, 1
    s_mul_i32 s70, s70, 6144
    s_mul_i32 s41, s52, 10240
    s_add_u32 s41, s41, s70
    s_add_u32 s42, s41, s69
    s_lshl_b32 s69, s73, 13
    s_add_u32 s43, s76, s69
    s_add_u32 s43, s43, 196608
    s_lshl_b32 s69, s2, 3
    s_add_u32 s69, s69, s3
    s_sub_u32 s70, s69, 1376
    s_cmp_ge_u32 s69, 1376
    s_cselect_b32 s69, s70, s69
    s_cselect_b32 s84, s36, s44
    s_cselect_b32 s85, s37, s45
    s_mov_b32 s86, 1409024
    s_cmov_b32 s86, 524288
    s_mov_b32 s87, 0x20000
    s_lshl_b32 s46, s69, 10
    s_add_u32 s46, s46, 0
    v_and_b32 v18, 7, v0
    v_lshlrev_b32 v18, 7, v18
    v_mov_b32 v17, 0
    v_and_b32 v1, 15, v0
    s_mul_i32 s34, s3, 768
    s_add_u32 s34, s34, 156160
    v_lshl_add_u32 v14, v1, 2, s34
    v_lshrrev_b32 v2, 5, v0
    v_lshl_add_u32 v1, v2, 4, v1
    s_lshr_b32 s69, s74, 1
    s_sub_u32 s69, s69, 8
    v_add_u32 v2, s69, v1
    s_mov_b32 s71, 241664
    v_bfe_u32 v3, v0, 4, 1
    v_lshlrev_b32 v3, 9, v3
    v_cmp_le_u32 vcc, 8, v1
    v_lshrrev_b32 v8, 5, v2
    v_mul_lo_u32 v8, v8, s71
    v_and_b32 v1, 31, v2
    v_lshl_add_u32 v1, v1, 4, v3
    v_add_u32 v8, v8, v1
    v_add_u32 v2, 32, v2
    v_lshrrev_b32 v9, 5, v2
    v_mul_lo_u32 v9, v9, s71
    v_and_b32 v1, 31, v2
    v_lshl_add_u32 v1, v1, 4, v3
    v_add_u32 v9, v9, v1
    v_add_u32 v2, 32, v2
    v_lshrrev_b32 v13, 5, v2
    v_mul_lo_u32 v13, v13, s71
    v_and_b32 v1, 31, v2
    v_lshl_add_u32 v1, v1, 4, v3
    v_add_u32 v13, v13, v1
    v_mov_b32 v1, 2147483648
    v_cndmask_b32 v8, v1, v8, vcc
    s_lshl_b32 s75, s66, 7
    s_lshl_b32 s72, s67, 2
    s_add_u32 s75, s75, s72
    s_lshr_b32 s78, s3, 1
    s_add_u32 s72, s72, s78
    s_add_u32 s75, s75, 8192
    s_mul_i32 s71, s73, 120832
    s_add_u32 s72, s72, 86
    s_lshl_b32 s72, s72, 10
    s_add_u32 s39, s71, s72
    s_waitcnt vmcnt(6)
    v_mov_b32 v52, 0
    v_mov_b32 v53, 0
    v_dot2c_f32_bf16 v52, s62, v48
    v_dot2c_f32_bf16 v53, v48, v48
    v_dot2c_f32_bf16 v52, s62, v49
    v_dot2c_f32_bf16 v53, v49, v49
    v_dot2c_f32_bf16 v52, s62, v50
    v_dot2c_f32_bf16 v53, v50, v50
    s_add_u32 m0, s60, s56
    s_mov_b64 exec, s[88:89]
    buffer_load_dwordx4 v4, s[4:7], s54 offen lds
    s_mov_b64 exec, -1
    v_dot2c_f32_bf16 v52, s62, v51
    v_dot2c_f32_bf16 v53, v51, v51
    s_nop 2
    v_add_f32_dpp v52, v52, v52 row_ror:1 row_mask:0xf bank_mask:0xf
    v_add_f32_dpp v53, v53, v53 row_ror:1 row_mask:0xf bank_mask:0xf
    s_nop 0
    v_add_f32_dpp v52, v52, v52 row_ror:2 row_mask:0xf bank_mask:0xf
    v_add_f32_dpp v53, v53, v53 row_ror:2 row_mask:0xf bank_mask:0xf
    s_nop 0
    v_add_f32_dpp v52, v52, v52 row_ror:4 row_mask:0xf bank_mask:0xf
    v_add_f32_dpp v53, v53, v53 row_ror:4 row_mask:0xf bank_mask:0xf
    buffer_load_dwordx4 v5, s[4:7], s54 offen offset:1024 lds
    v_add_f32_dpp v52, v52, v52 row_ror:8 row_mask:0xf bank_mask:0xf
    v_add_f32_dpp v53, v53, v53 row_ror:8 row_mask:0xf bank_mask:0xf
    v_mov_b32 v54, v52
    v_mov_b32 v55, v53
    s_nop 0
    v_permlane16_swap_b32 v52, v54
    v_permlane16_swap_b32 v53, v55
    v_add_f32 v52, v52, v54
    v_add_f32 v53, v53, v55
    buffer_load_dwordx4 v6, s[4:7], s54 offen offset:2048 lds
    v_mov_b32 v54, v52
    v_mov_b32 v55, v53
    s_nop 0
    v_permlane32_swap_b32 v52, v54
    v_permlane32_swap_b32 v53, v55
    v_add_f32 v52, v52, v54
    v_add_f32 v53, v53, v55
    v_mul_f32 v52, 989855744, v52
    v_mul_f32 v53, 989855744, v53
    s_add_u32 m0, s60, s57
    s_nop 0
    buffer_load_dwordx4 v7, s[8:11], s55 offen lds
    v_fma_f32 v53, -v52, v52, v53
    v_max_f32 v53, 0, v53
    v_cvt_pk_bf16_f32 v53, v53, v53
    v_lshlrev_b32 v53, 16, v53
    v_add_f32 v53, 925353388, v53
    v_cvt_pk_bf16_f32 v53, v53, v53
    v_lshlrev_b32 v53, 16, v53
    v_sqrt_f32 v53, v53
    buffer_load_dwordx4 v7, s[8:11], s55 offen offset:1024 lds
    s_lshl_b32 s69, s2, 5
    s_lshl_b32 s70, s3, 2
    s_add_u32 s69, s69, s70
    s_add_u32 s69, s69, 16384
    v_cvt_pk_bf16_f32 v53, -v52, v53
    s_mov_b64 exec, 1
    buffer_store_dword v53, off, s[80:83], s69 sc1
    s_mov_b64 exec, -1
    buffer_load_dwordx4 v7, s[8:11], s55 offen offset:2048 lds
    s_add_u32 s60, s60, 53504
    s_cmp_eq_u32 s60, 160512
    s_cselect_b32 s60, 0, s60
    s_lshl_b32 s54, s49, 7
    s_add_u32 s54, s54, s50
    s_mul_i32 s55, s49, s53
    s_add_u32 s55, s55, s51
    s_add_u32 s49, s49, 1
    s_and_b32 s49, s49, 7
    s_mul_i32 s45, s53, -7
    s_mov_b32 s49, 15
    s_and_b32 s0, s0, 62
    s_or_b32 s0, s0, 64
    s_ff1_i32_b32 s63, s0
    s_mov_b32 s77, 53504
    s_mov_b32 s37, 4294860288
    global_load_dword v24, v17, s[28:29] sc1
    s_waitcnt vmcnt(8) lgkmcnt(0)
    s_barrier
    ds_read_b64_tr_b16 a[24:25], v15 offset:0
    ds_read_b64_tr_b16 a[26:27], v15 offset:512
    ds_read_b128 a[0:3], v11 offset:0
    s_add_u32 m0, s60, s56
    s_mov_b64 exec, s[88:89]
    buffer_load_dwordx4 v4, s[4:7], s54 offen lds
    s_mov_b64 exec, -1
    ds_read_b64_tr_b16 a[28:29], v15 offset:1024
    ds_read_b64_tr_b16 a[30:31], v15 offset:1536
    ds_read_b64_tr_b16 a[32:33], v15 offset:2048
    ds_read_b64_tr_b16 a[34:35], v15 offset:2560
    ds_read_b128 a[4:7], v11 offset:2048
    buffer_load_dwordx4 v5, s[4:7], s54 offen offset:1024 lds
    ds_read_b128 a[8:11], v11 offset:4096
    ds_read_b128 a[12:15], v11 offset:6144
    ds_read_b128 a[16:19], v11 offset:8192
    buffer_load_dwordx4 v6, s[4:7], s54 offen offset:2048 lds
    ds_read_b128 a[20:23], v11 offset:10240
    s_add_u32 s54, s54, 128
    s_and_b32 s71, s54, 1023
    s_or_b32 s54, s71, s50
    s_cmp_eq_u32 s60, s77
    s_cselect_b32 s61, s37, s77
L_aloop:
    s_waitcnt lgkmcnt(4)
    v_mfma_f32_16x16x32_bf16 v[80:83], a[24:27], a[0:3], v[80:83]
    ds_read_b64_tr_b16 a[60:61], v15 offset:12288
    ds_read_b64_tr_b16 a[62:63], v15 offset:12800
    v_add_u32 v11, s61, v11
    v_mfma_f32_16x16x32_bf16 v[104:107], a[28:31], a[0:3], v[104:107]
    ds_read_b128 a[36:39], v12 offset:0
    v_mfma_f32_16x16x32_bf16 v[128:131], a[0:3], a[32:35], v[128:131]
    s_add_u32 m0, s60, s57
    s_nop 0
    buffer_load_dwordx4 v7, s[8:11], s55 offen lds
    v_mfma_f32_16x16x32_bf16 v[84:87], a[24:27], a[4:7], v[84:87]
    ds_read_b64_tr_b16 a[64:65], v15 offset:13312
    ds_read_b64_tr_b16 a[66:67], v15 offset:13824
    v_mfma_f32_16x16x32_bf16 v[108:111], a[28:31], a[4:7], v[108:111]
    v_mfma_f32_16x16x32_bf16 v[132:135], a[4:7], a[32:35], v[132:135]
    ds_read_b64_tr_b16 a[68:69], v15 offset:14336
    ds_read_b64_tr_b16 a[70:71], v15 offset:14848
    s_waitcnt lgkmcnt(9)
    v_mfma_f32_16x16x32_bf16 v[88:91], a[24:27], a[8:11], v[88:91]
    ds_read_b128 a[40:43], v12 offset:2048
    v_mfma_f32_16x16x32_bf16 v[112:115], a[28:31], a[8:11], v[112:115]
    buffer_load_dwordx4 v7, s[8:11], s55 offen offset:1024 lds
    v_mfma_f32_16x16x32_bf16 v[136:139], a[8:11], a[32:35], v[136:139]
    ds_read_b128 a[44:47], v12 offset:4096
    v_mfma_f32_16x16x32_bf16 v[92:95], a[24:27], a[12:15], v[92:95]
    v_mfma_f32_16x16x32_bf16 v[116:119], a[28:31], a[12:15], v[116:119]
    ds_read_b128 a[48:51], v12 offset:6144
    v_mfma_f32_16x16x32_bf16 v[140:143], a[12:15], a[32:35], v[140:143]
    ds_read_b128 a[52:55], v12 offset:8192
    s_waitcnt lgkmcnt(11)
    v_mfma_f32_16x16x32_bf16 v[96:99], a[24:27], a[16:19], v[96:99]
    v_mfma_f32_16x16x32_bf16 v[120:123], a[28:31], a[16:19], v[120:123]
    ds_read_b128 a[56:59], v12 offset:10240
    buffer_load_dwordx4 v7, s[8:11], s55 offen offset:2048 lds
    v_mfma_f32_16x16x32_bf16 v[144:147], a[16:19], a[32:35], v[144:147]
    s_cmp_eq_u32 s71, 0
    s_cselect_b32 s72, s45, s53
    s_add_u32 s55, s55, s72
    s_cmp_eq_u32 s60, 107008
    s_cselect_b32 s72, s37, s77
    s_add_u32 s60, s60, s72
    v_mfma_f32_16x16x32_bf16 v[100:103], a[24:27], a[20:23], v[100:103]
    v_add_u32 v12, s61, v12
    v_mfma_f32_16x16x32_bf16 v[124:127], a[28:31], a[20:23], v[124:127]
    v_add_u32 v15, s61, v15
    v_mfma_f32_16x16x32_bf16 v[148:151], a[20:23], a[32:35], v[148:151]
    s_add_u32 s48, s48, 1
    s_cmp_lt_u32 s48, s63
    s_waitcnt vmcnt(6) lgkmcnt(0)
    v_mfma_f32_16x16x32_bf16 v[80:83], a[60:63], a[36:39], v[80:83]
    s_cbranch_scc0 L_aexit
    s_barrier
L_aback:
    v_mfma_f32_16x16x32_bf16 v[104:107], a[64:67], a[36:39], v[104:107]
    ds_read_b64_tr_b16 a[24:25], v15 offset:0
    ds_read_b64_tr_b16 a[26:27], v15 offset:512
    v_mfma_f32_16x16x32_bf16 v[128:131], a[36:39], a[68:71], v[128:131]
    ds_read_b128 a[0:3], v11 offset:0
    v_mfma_f32_16x16x32_bf16 v[84:87], a[60:63], a[40:43], v[84:87]
    s_add_u32 m0, s60, s56
    s_mov_b64 exec, s[88:89]
    buffer_load_dwordx4 v4, s[4:7], s54 offen lds
    s_mov_b64 exec, -1
    v_mfma_f32_16x16x32_bf16 v[108:111], a[64:67], a[40:43], v[108:111]
    ds_read_b64_tr_b16 a[28:29], v15 offset:1024
    ds_read_b64_tr_b16 a[30:31], v15 offset:1536
    v_mfma_f32_16x16x32_bf16 v[132:135], a[40:43], a[68:71], v[132:135]
    v_mfma_f32_16x16x32_bf16 v[88:91], a[60:63], a[44:47], v[88:91]
    ds_read_b64_tr_b16 a[32:33], v15 offset:2048
    ds_read_b64_tr_b16 a[34:35], v15 offset:2560
    v_mfma_f32_16x16x32_bf16 v[112:115], a[64:67], a[44:47], v[112:115]
    v_mfma_f32_16x16x32_bf16 v[136:139], a[44:47], a[68:71], v[136:139]
    ds_read_b128 a[4:7], v11 offset:2048
    buffer_load_dwordx4 v5, s[4:7], s54 offen offset:1024 lds
    v_mfma_f32_16x16x32_bf16 v[92:95], a[60:63], a[48:51], v[92:95]
    ds_read_b128 a[8:11], v11 offset:4096
    v_mfma_f32_16x16x32_bf16 v[116:119], a[64:67], a[48:51], v[116:119]
    v_mfma_f32_16x16x32_bf16 v[140:143], a[48:51], a[68:71], v[140:143]
    ds_read_b128 a[12:15], v11 offset:6144
    v_mfma_f32_16x16x32_bf16 v[96:99], a[60:63], a[52:55], v[96:99]
    v_mfma_f32_16x16x32_bf16 v[120:123], a[64:67], a[52:55], v[120:123]
    ds_read_b128 a[16:19], v11 offset:8192
    v_mfma_f32_16x16x32_bf16 v[144:147], a[52:55], a[68:71], v[144:147]
    buffer_load_dwordx4 v6, s[4:7], s54 offen offset:2048 lds
    v_mfma_f32_16x16x32_bf16 v[100:103], a[60:63], a[56:59], v[100:103]
    ds_read_b128 a[20:23], v11 offset:10240
    v_mfma_f32_16x16x32_bf16 v[124:127], a[64:67], a[56:59], v[124:127]
    s_add_u32 s54, s54, 128
    s_and_b32 s71, s54, 1023
    s_or_b32 s54, s71, s50
    v_mfma_f32_16x16x32_bf16 v[148:151], a[56:59], a[68:71], v[148:151]
    s_cmp_eq_u32 s60, s77
    s_cselect_b32 s61, s37, s77
    s_branch L_aloop
L_aexit:
    s_barrier
    s_cmp_lt_u32 s48, 6
    s_cbranch_scc1 L_ah
    v_mfma_f32_16x16x32_bf16 v[104:107], a[64:67], a[36:39], v[104:107]
    ds_read_b64_tr_b16 a[24:25], v15 offset:0
    ds_read_b64_tr_b16 a[26:27], v15 offset:512
    v_mfma_f32_16x16x32_bf16 v[128:131], a[36:39], a[68:71], v[128:131]
    ds_read_b128 a[0:3], v11 offset:0
    v_readfirstlane_b32 s68, v24
    s_mov_b32 s69, 0
L_taga:
    s_nop 2
    s_cmp_lg_u32 s68, 0
    s_cbranch_scc1 L_tagoka
    v_mov_b32 v1, 0
    global_load_dword v24, v1, s[28:29] sc1
    s_waitcnt vmcnt(0)
    v_readfirstlane_b32 s68, v24
    s_add_u32 s69, s69, 1
    s_cmp_lt_u32 s69, 262144
    s_cbranch_scc1 L_taga
L_tagoka:
    s_mov_b32 s54, s32
    s_mov_b32 s56, s33
    buffer_load_dword v24, v22, s[80:83], 0 offen sc1
    v_mfma_f32_16x16x32_bf16 v[84:87], a[60:63], a[40:43], v[84:87]
    s_add_u32 m0, s60, s56
    s_nop 0
    buffer_load_dwordx4 v25, s[16:19], s54 offen lds
    v_mfma_f32_16x16x32_bf16 v[108:111], a[64:67], a[40:43], v[108:111]
    ds_read_b64_tr_b16 a[28:29], v15 offset:1024
    ds_read_b64_tr_b16 a[30:31], v15 offset:1536
    v_mfma_f32_16x16x32_bf16 v[132:135], a[40:43], a[68:71], v[132:135]
    v_mfma_f32_16x16x32_bf16 v[88:91], a[60:63], a[44:47], v[88:91]
    ds_read_b64_tr_b16 a[32:33], v15 offset:2048
    ds_read_b64_tr_b16 a[34:35], v15 offset:2560
    v_mfma_f32_16x16x32_bf16 v[112:115], a[64:67], a[44:47], v[112:115]
    v_mfma_f32_16x16x32_bf16 v[136:139], a[44:47], a[68:71], v[136:139]
    ds_read_b128 a[4:7], v11 offset:2048
    buffer_load_dwordx4 v26, s[16:19], s54 offen offset:1024 lds
    v_mfma_f32_16x16x32_bf16 v[92:95], a[60:63], a[48:51], v[92:95]
    ds_read_b128 a[8:11], v11 offset:4096
    v_mfma_f32_16x16x32_bf16 v[116:119], a[64:67], a[48:51], v[116:119]
    v_mfma_f32_16x16x32_bf16 v[140:143], a[48:51], a[68:71], v[140:143]
    ds_read_b128 a[12:15], v11 offset:6144
    v_mfma_f32_16x16x32_bf16 v[96:99], a[60:63], a[52:55], v[96:99]
    v_mfma_f32_16x16x32_bf16 v[120:123], a[64:67], a[52:55], v[120:123]
    ds_read_b128 a[16:19], v11 offset:8192
    v_mfma_f32_16x16x32_bf16 v[144:147], a[52:55], a[68:71], v[144:147]
    buffer_load_dwordx4 v27, s[16:19], s54 offen offset:2048 lds
    v_mfma_f32_16x16x32_bf16 v[100:103], a[60:63], a[56:59], v[100:103]
    ds_read_b128 a[20:23], v11 offset:10240
    v_mfma_f32_16x16x32_bf16 v[124:127], a[64:67], a[56:59], v[124:127]
    v_mfma_f32_16x16x32_bf16 v[148:151], a[56:59], a[68:71], v[148:151]
    s_cmp_eq_u32 s60, s77
    s_cselect_b32 s61, s37, s77
L_atail:
    s_waitcnt lgkmcnt(4)
    v_mfma_f32_16x16x32_bf16 v[80:83], a[24:27], a[0:3], v[80:83]
    ds_read_b64_tr_b16 a[60:61], v15 offset:12288
    ds_read_b64_tr_b16 a[62:63], v15 offset:12800
    v_add_u32 v11, s61, v11
    v_mfma_f32_16x16x32_bf16 v[104:107], a[28:31], a[0:3], v[104:107]
    ds_read_b128 a[36:39], v12 offset:0
    v_mfma_f32_16x16x32_bf16 v[128:131], a[0:3], a[32:35], v[128:131]
    buffer_load_dwordx4 v28, s[16:19], s54 offen offset:3072 lds
    v_mfma_f32_16x16x32_bf16 v[84:87], a[24:27], a[4:7], v[84:87]
    ds_read_b64_tr_b16 a[64:65], v15 offset:13312
    ds_read_b64_tr_b16 a[66:67], v15 offset:13824
    v_mfma_f32_16x16x32_bf16 v[108:111], a[28:31], a[4:7], v[108:111]
    v_mfma_f32_16x16x32_bf16 v[132:135], a[4:7], a[32:35], v[132:135]
    ds_read_b64_tr_b16 a[68:69], v15 offset:14336
    ds_read_b64_tr_b16 a[70:71], v15 offset:14848
    s_waitcnt lgkmcnt(9)
    v_mfma_f32_16x16x32_bf16 v[88:91], a[24:27], a[8:11], v[88:91]
    ds_read_b128 a[40:43], v12 offset:2048
    v_mfma_f32_16x16x32_bf16 v[112:115], a[28:31], a[8:11], v[112:115]
    s_add_u32 m0, m0, 4096
    s_add_u32 s54, s54, 32768
    buffer_load_dwordx4 v25, s[16:19], s54 offen lds
    v_mfma_f32_16x16x32_bf16 v[136:139], a[8:11], a[32:35], v[136:139]
    ds_read_b128 a[44:47], v12 offset:4096
    v_mfma_f32_16x16x32_bf16 v[92:95], a[24:27], a[12:15], v[92:95]
    v_mfma_f32_16x16x32_bf16 v[116:119], a[28:31], a[12:15], v[116:119]
    ds_read_b128 a[48:51], v12 offset:6144
    v_mfma_f32_16x16x32_bf16 v[140:143], a[12:15], a[32:35], v[140:143]
    ds_read_b128 a[52:55], v12 offset:8192
    s_waitcnt lgkmcnt(11)
    v_mfma_f32_16x16x32_bf16 v[96:99], a[24:27], a[16:19], v[96:99]
    v_mfma_f32_16x16x32_bf16 v[120:123], a[28:31], a[16:19], v[120:123]
    ds_read_b128 a[56:59], v12 offset:10240
    buffer_load_dwordx4 v26, s[16:19], s54 offen offset:1024 lds
    s_add_u32 s54, s54, 65536
    v_mfma_f32_16x16x32_bf16 v[144:147], a[16:19], a[32:35], v[144:147]
    s_cmp_eq_u32 s60, 107008
    s_cselect_b32 s72, s37, s77
    s_add_u32 s60, s60, s72
    v_mfma_f32_16x16x32_bf16 v[100:103], a[24:27], a[20:23], v[100:103]
    v_add_u32 v12, s61, v12
    v_mfma_f32_16x16x32_bf16 v[124:127], a[28:31], a[20:23], v[124:127]
    v_add_u32 v15, s61, v15
    v_mfma_f32_16x16x32_bf16 v[148:151], a[20:23], a[32:35], v[148:151]
    s_add_u32 s48, s48, 1
    s_cmp_lt_u32 s48, 8
    s_waitcnt vmcnt(6) lgkmcnt(0)
    v_mfma_f32_16x16x32_bf16 v[80:83], a[60:63], a[36:39], v[80:83]
    s_cbranch_scc0 L_atexit
    s_barrier
    v_mfma_f32_16x16x32_bf16 v[104:107], a[64:67], a[36:39], v[104:107]
    ds_read_b64_tr_b16 a[24:25], v15 offset:0
    ds_read_b64_tr_b16 a[26:27], v15 offset:512
    v_mfma_f32_16x16x32_bf16 v[128:131], a[36:39], a[68:71], v[128:131]
    ds_read_b128 a[0:3], v11 offset:0
    s_mov_b32 s69, 0
L_f0a:
    v_cmp_ne_u32 vcc, s68, v24
    s_nop 3
    s_cbranch_vccz L_f0oka
    buffer_load_dword v24, v22, s[80:83], 0 offen sc1
    s_waitcnt vmcnt(0)
    s_add_u32 s69, s69, 1
    s_cmp_lt_u32 s69, 262144
    s_cbranch_scc1 L_f0a
L_f0oka:
    buffer_load_dword v16, v30, s[80:83], 0 offen sc1
    buffer_load_dword v17, v31, s[80:83], 0 offen sc1
    buffer_load_dword v18, v32, s[80:83], 0 offen sc1
    buffer_load_dword v19, v33, s[80:83], 0 offen sc1
    buffer_load_dword v20, v34, s[80:83], 0 offen sc1
    buffer_load_dword v21, v35, s[80:83], 0 offen sc1
    v_mfma_f32_16x16x32_bf16 v[84:87], a[60:63], a[40:43], v[84:87]
    s_add_u32 m0, s60, s56
    s_nop 0
    buffer_load_dwordx4 v25, s[16:19], s54 offen lds
    v_mfma_f32_16x16x32_bf16 v[108:111], a[64:67], a[40:43], v[108:111]
    ds_read_b64_tr_b16 a[28:29], v15 offset:1024
    ds_read_b64_tr_b16 a[30:31], v15 offset:1536
    v_mfma_f32_16x16x32_bf16 v[132:135], a[40:43], a[68:71], v[132:135]
    v_mfma_f32_16x16x32_bf16 v[88:91], a[60:63], a[44:47], v[88:91]
    ds_read_b64_tr_b16 a[32:33], v15 offset:2048
    ds_read_b64_tr_b16 a[34:35], v15 offset:2560
    v_mfma_f32_16x16x32_bf16 v[112:115], a[64:67], a[44:47], v[112:115]
    v_mfma_f32_16x16x32_bf16 v[136:139], a[44:47], a[68:71], v[136:139]
    ds_read_b128 a[4:7], v11 offset:2048
    buffer_load_dwordx4 v26, s[16:19], s54 offen offset:1024 lds
    v_mfma_f32_16x16x32_bf16 v[92:95], a[60:63], a[48:51], v[92:95]
    ds_read_b128 a[8:11], v11 offset:4096
    v_mfma_f32_16x16x32_bf16 v[116:119], a[64:67], a[48:51], v[116:119]
    v_mfma_f32_16x16x32_bf16 v[140:143], a[48:51], a[68:71], v[140:143]
    ds_read_b128 a[12:15], v11 offset:6144
    v_mfma_f32_16x16x32_bf16 v[96:99], a[60:63], a[52:55], v[96:99]
    v_mfma_f32_16x16x32_bf16 v[120:123], a[64:67], a[52:55], v[120:123]
    ds_read_b128 a[16:19], v11 offset:8192
    v_mfma_f32_16x16x32_bf16 v[144:147], a[52:55], a[68:71], v[144:147]
    buffer_load_dwordx4 v27, s[16:19], s54 offen offset:2048 lds
    v_mfma_f32_16x16x32_bf16 v[100:103], a[60:63], a[56:59], v[100:103]
    ds_read_b128 a[20:23], v11 offset:10240
    v_mfma_f32_16x16x32_bf16 v[124:127], a[64:67], a[56:59], v[124:127]
    v_mfma_f32_16x16x32_bf16 v[148:151], a[56:59], a[68:71], v[148:151]
    s_cmp_eq_u32 s60, s77
    s_cselect_b32 s61, s37, s77
    s_branch L_atail
L_atexit:
    s_barrier
    v_and_b32 v31, 48, v0
    v_add_u32 v31, s34, v31
    v_mfma_f32_16x16x32_bf16 v[104:107], a[64:67], a[36:39], v[104:107]
    v_and_b32 v152, 0xffff0000, v16
    v_max_f32 v152, 981668463, v152
    v_mfma_f32_16x16x32_bf16 v[128:131], a[36:39], a[68:71], v[128:131]
    v_rcp_f32 v152, v152
    v_lshlrev_b32 v48, 16, v16
    v_mfma_f32_16x16x32_bf16 v[84:87], a[60:63], a[40:43], v[84:87]
    ds_write2_b32 v14, v48, v152 offset0:0 offset1:96
    v_mfma_f32_16x16x32_bf16 v[108:111], a[64:67], a[40:43], v[108:111]
    v_and_b32 v154, 0xffff0000, v17
    v_max_f32 v154, 981668463, v154
    v_mfma_f32_16x16x32_bf16 v[132:135], a[40:43], a[68:71], v[132:135]
    v_rcp_f32 v154, v154
    v_lshlrev_b32 v50, 16, v17
    v_mfma_f32_16x16x32_bf16 v[88:91], a[60:63], a[44:47], v[88:91]
    ds_write2_b32 v14, v50, v154 offset0:16 offset1:112
    v_mfma_f32_16x16x32_bf16 v[112:115], a[64:67], a[44:47], v[112:115]
    v_and_b32 v156, 0xffff0000, v18
    v_max_f32 v156, 981668463, v156
    v_mfma_f32_16x16x32_bf16 v[136:139], a[44:47], a[68:71], v[136:139]
    v_rcp_f32 v156, v156
    v_lshlrev_b32 v52, 16, v18
    v_mfma_f32_16x16x32_bf16 v[92:95], a[60:63], a[48:51], v[92:95]
    ds_write2_b32 v14, v52, v156 offset0:32 offset1:128
    v_mfma_f32_16x16x32_bf16 v[116:119], a[64:67], a[48:51], v[116:119]
    v_and_b32 v158, 0xffff0000, v19
    v_max_f32 v158, 981668463, v158
    v_mfma_f32_16x16x32_bf16 v[140:143], a[48:51], a[68:71], v[140:143]
    v_rcp_f32 v158, v158
    v_lshlrev_b32 v54, 16, v19
    v_mfma_f32_16x16x32_bf16 v[96:99], a[60:63], a[52:55], v[96:99]
    ds_write2_b32 v14, v54, v158 offset0:48 offset1:144
    v_mfma_f32_16x16x32_bf16 v[120:123], a[64:67], a[52:55], v[120:123]
    v_and_b32 v32, 0xffff0000, v20
    v_max_f32 v32, 981668463, v32
    v_mfma_f32_16x16x32_bf16 v[144:147], a[52:55], a[68:71], v[144:147]
    v_rcp_f32 v32, v32
    v_lshlrev_b32 v56, 16, v20
    v_mfma_f32_16x16x32_bf16 v[100:103], a[60:63], a[56:59], v[100:103]
    ds_write2_b32 v14, v56, v32 offset0:64 offset1:160
    v_mfma_f32_16x16x32_bf16 v[124:127], a[64:67], a[56:59], v[124:127]
    v_and_b32 v34, 0xffff0000, v21
    v_max_f32 v34, 981668463, v34
    v_mfma_f32_16x16x32_bf16 v[148:151], a[56:59], a[68:71], v[148:151]
    v_rcp_f32 v34, v34
    v_lshlrev_b32 v58, 16, v21
    ds_write2_b32 v14, v58, v34 offset0:80 offset1:176
    v_add_u32 v4, s1, v10
    v_add_u32 v6, 107008, v4
    v_xor_b32 v7, 64, v6
    v_add_u32 v11, 14336, v25
    ds_read_b128 v[70:73], v31 offset:0
    ds_read_b128 v[74:77], v31 offset:384
    ds_read_b128 v[16:19], v31 offset:64
    ds_read_b128 v[20:23], v31 offset:448
    v_mov_b32 v68, v128
    v_mov_b32 v69, v128
    v_mov_b32_dpp v64, v104 row_newbcast:0 row_mask:0xf bank_mask:0xf
    v_mov_b32_dpp v65, v105 row_newbcast:0 row_mask:0xf bank_mask:0xf
    v_mov_b32_dpp v66, v106 row_newbcast:0 row_mask:0xf bank_mask:0xf
    v_mov_b32_dpp v67, v107 row_newbcast:0 row_mask:0xf bank_mask:0xf
    v_permlane16_swap_b32 v68, v69
    v_mov_b32_dpp v60, v80 row_newbcast:0 row_mask:0xf bank_mask:0xf
    v_mov_b32_dpp v61, v81 row_newbcast:0 row_mask:0xf bank_mask:0xf
    v_mov_b32 v69, v68
    v_mov_b32_dpp v62, v82 row_newbcast:0 row_mask:0xf bank_mask:0xf
    v_mov_b32_dpp v63, v83 row_newbcast:0 row_mask:0xf bank_mask:0xf
    v_permlane32_swap_b32 v68, v69
    v_pk_fma_f32 v[80:81], v[60:61], v[48:49], v[80:81] op_sel_hi:[1,0,1]
    v_pk_fma_f32 v[82:83], v[62:63], v[48:49], v[82:83] op_sel_hi:[1,0,1]
    v_pk_fma_f32 v[84:85], v[60:61], v[50:51], v[84:85] op_sel_hi:[1,0,1]
    v_pk_fma_f32 v[86:87], v[62:63], v[50:51], v[86:87] op_sel_hi:[1,0,1]
    ds_read_b64_tr_b16 a[0:1], v6 offset:0
    ds_read_b64_tr_b16 a[2:3], v6 offset:1024
    v_pk_fma_f32 v[88:89], v[60:61], v[52:53], v[88:89] op_sel_hi:[1,0,1]
    v_pk_fma_f32 v[90:91], v[62:63], v[52:53], v[90:91] op_sel_hi:[1,0,1]
    v_pk_fma_f32 v[92:93], v[60:61], v[54:55], v[92:93] op_sel_hi:[1,0,1]
    v_pk_fma_f32 v[94:95], v[62:63], v[54:55], v[94:95] op_sel_hi:[1,0,1]
    ds_read_b64_tr_b16 a[4:5], v7 offset:0
    ds_read_b64_tr_b16 a[6:7], v7 offset:1024
    v_pk_fma_f32 v[96:97], v[60:61], v[56:57], v[96:97] op_sel_hi:[1,0,1]
    v_pk_fma_f32 v[98:99], v[62:63], v[56:57], v[98:99] op_sel_hi:[1,0,1]
    v_pk_fma_f32 v[100:101], v[60:61], v[58:59], v[100:101] op_sel_hi:[1,0,1]
    v_pk_fma_f32 v[102:103], v[62:63], v[58:59], v[102:103] op_sel_hi:[1,0,1]
    ds_read_b64_tr_b16 a[8:9], v6 offset:2048
    ds_read_b64_tr_b16 a[10:11], v6 offset:3072
    v_pk_fma_f32 v[104:105], v[64:65], v[48:49], v[104:105] op_sel_hi:[1,0,1]
    v_pk_fma_f32 v[106:107], v[66:67], v[48:49], v[106:107] op_sel_hi:[1,0,1]
    v_pk_fma_f32 v[108:109], v[64:65], v[50:51], v[108:109] op_sel_hi:[1,0,1]
    v_pk_fma_f32 v[110:111], v[66:67], v[50:51], v[110:111] op_sel_hi:[1,0,1]
    ds_read_b64_tr_b16 a[12:13], v7 offset:2048
    ds_read_b64_tr_b16 a[14:15], v7 offset:3072
    v_pk_fma_f32 v[112:113], v[64:65], v[52:53], v[112:113] op_sel_hi:[1,0,1]
    v_pk_fma_f32 v[114:115], v[66:67], v[52:53], v[114:115] op_sel_hi:[1,0,1]
    v_pk_fma_f32 v[116:117], v[64:65], v[54:55], v[116:117] op_sel_hi:[1,0,1]
    v_pk_fma_f32 v[118:119], v[66:67], v[54:55], v[118:119] op_sel_hi:[1,0,1]
    ds_read_b64_tr_b16 a[16:17], v6 offset:4096
    ds_read_b64_tr_b16 a[18:19], v6 offset:5120
    v_pk_fma_f32 v[120:121], v[64:65], v[56:57], v[120:121] op_sel_hi:[1,0,1]
    v_pk_fma_f32 v[122:123], v[66:67], v[56:57], v[122:123] op_sel_hi:[1,0,1]
    v_pk_fma_f32 v[124:125], v[64:65], v[58:59], v[124:125] op_sel_hi:[1,0,1]
    v_pk_fma_f32 v[126:127], v[66:67], v[58:59], v[126:127] op_sel_hi:[1,0,1]
    ds_read_b64_tr_b16 a[20:21], v7 offset:4096
    ds_read_b64_tr_b16 a[22:23], v7 offset:5120
    v_cvt_pk_bf16_f32 v80, v80, v81
    v_cvt_pk_bf16_f32 v81, v82, v83
    v_cvt_pk_bf16_f32 v82, v84, v85
    v_cvt_pk_bf16_f32 v83, v86, v87
    ds_read_b64_tr_b16 a[24:25], v6 offset:6144
    ds_read_b64_tr_b16 a[26:27], v6 offset:7168
    v_cvt_pk_bf16_f32 v84, v88, v89
    v_cvt_pk_bf16_f32 v85, v90, v91
    v_cvt_pk_bf16_f32 v86, v92, v93
    v_cvt_pk_bf16_f32 v87, v94, v95
    ds_read_b64_tr_b16 a[28:29], v7 offset:6144
    ds_read_b64_tr_b16 a[30:31], v7 offset:7168
    v_cvt_pk_bf16_f32 v88, v96, v97
    v_cvt_pk_bf16_f32 v89, v98, v99
    v_cvt_pk_bf16_f32 v90, v100, v101
    v_cvt_pk_bf16_f32 v91, v102, v103
    ds_read_b64_tr_b16 a[32:33], v6 offset:8192
    ds_read_b64_tr_b16 a[34:35], v6 offset:9216
    ds_read_b64_tr_b16 a[36:37], v7 offset:8192
    ds_read_b64_tr_b16 a[38:39], v7 offset:9216
    ds_read_b64_tr_b16 a[40:41], v6 offset:10240
    ds_read_b64_tr_b16 a[42:43], v6 offset:11264
    ds_read_b64_tr_b16 a[44:45], v7 offset:10240
    ds_read_b64_tr_b16 a[46:47], v7 offset:11264
    ds_read_b128 v[92:95], v31 offset:128
    ds_read_b128 v[96:99], v31 offset:512
    v_pk_mul_f32 v[104:105], v[104:105], v[152:153] op_sel_hi:[1,0]
    v_pk_mul_f32 v[106:107], v[106:107], v[152:153] op_sel_hi:[1,0]
    v_pk_mul_f32 v[108:109], v[108:109], v[154:155] op_sel_hi:[1,0]
    v_pk_mul_f32 v[110:111], v[110:111], v[154:155] op_sel_hi:[1,0]
    v_pk_mul_f32 v[112:113], v[112:113], v[156:157] op_sel_hi:[1,0]
    v_pk_mul_f32 v[114:115], v[114:115], v[156:157] op_sel_hi:[1,0]
    v_pk_mul_f32 v[116:117], v[116:117], v[158:159] op_sel_hi:[1,0]
    v_pk_mul_f32 v[118:119], v[118:119], v[158:159] op_sel_hi:[1,0]
    v_pk_mul_f32 v[120:121], v[120:121], v[32:33] op_sel_hi:[1,0]
    v_pk_mul_f32 v[122:123], v[122:123], v[32:33] op_sel_hi:[1,0]
    v_pk_mul_f32 v[124:125], v[124:125], v[34:35] op_sel_hi:[1,0]
    v_pk_mul_f32 v[126:127], v[126:127], v[34:35] op_sel_hi:[1,0]
    v_mul_f32 v48, 1052289595, v152
    v_mul_f32 v50, 1052289595, v154
    v_mul_f32 v52, 1052289595, v156
    v_mul_f32 v54, 1052289595, v158
    v_mul_f32 v56, 1052289595, v32
    v_mul_f32 v58, 1052289595, v34
    v_cvt_pk_bf16_f32 v104, v104, v105
    v_cvt_pk_bf16_f32 v105, v106, v107
    v_cvt_pk_bf16_f32 v106, v108, v109
    v_cvt_pk_bf16_f32 v107, v110, v111
    v_cvt_pk_bf16_f32 v108, v112, v113
    v_cvt_pk_bf16_f32 v109, v114, v115
    v_cvt_pk_bf16_f32 v110, v116, v117
    v_cvt_pk_bf16_f32 v111, v118, v119
    v_cvt_pk_bf16_f32 v112, v120, v121
    v_cvt_pk_bf16_f32 v113, v122, v123
    v_cvt_pk_bf16_f32 v114, v124, v125
    v_cvt_pk_bf16_f32 v115, v126, v127
    s_waitcnt lgkmcnt(0)
    v_pk_fma_f32 v[128:129], v[70:71], v[68:69], v[128:129] op_sel_hi:[1,0,1]
    v_pk_fma_f32 v[130:131], v[72:73], v[68:69], v[130:131] op_sel_hi:[1,0,1]
    v_pk_fma_f32 v[132:133], v[16:17], v[68:69], v[132:133] op_sel_hi:[1,0,1]
    v_pk_fma_f32 v[134:135], v[18:19], v[68:69], v[134:135] op_sel_hi:[1,0,1]
    v_pk_fma_f32 v[136:137], v[92:93], v[68:69], v[136:137] op_sel_hi:[1,0,1]
    v_pk_fma_f32 v[138:139], v[94:95], v[68:69], v[138:139] op_sel_hi:[1,0,1]
    v_pk_mul_f32 v[128:129], v[128:129], v[74:75]
    v_pk_mul_f32 v[130:131], v[130:131], v[76:77]
    v_pk_mul_f32 v[132:133], v[132:133], v[20:21]
    v_pk_mul_f32 v[134:135], v[134:135], v[22:23]
    v_pk_mul_f32 v[136:137], v[136:137], v[96:97]
    v_pk_mul_f32 v[138:139], v[138:139], v[98:99]
    ds_read_b128 v[70:73], v31 offset:192
    ds_read_b128 v[74:77], v31 offset:576
    ds_read_b128 v[16:19], v31 offset:256
    ds_read_b128 v[20:23], v31 offset:640
    ds_read_b128 v[92:95], v31 offset:320
    ds_read_b128 v[96:99], v31 offset:704
    v_cvt_pk_bf16_f32 v130, v130, v131
    v_cvt_pk_bf16_f32 v131, v128, v129
    v_swap_b32 v130, v131
    v_cvt_pk_bf16_f32 v132, v132, v133
    v_cvt_pk_bf16_f32 v133, v134, v135
    v_cvt_pk_bf16_f32 v134, v136, v137
    v_cvt_pk_bf16_f32 v135, v138, v139
    s_waitcnt vmcnt(0) lgkmcnt(0)
    s_barrier
    s_mov_b32 s74, 2
    v_pk_fma_f32 v[140:141], v[70:71], v[68:69], v[140:141] op_sel_hi:[1,0,1]
    v_pk_fma_f32 v[142:143], v[72:73], v[68:69], v[142:143] op_sel_hi:[1,0,1]
    v_pk_fma_f32 v[144:145], v[16:17], v[68:69], v[144:145] op_sel_hi:[1,0,1]
    v_pk_fma_f32 v[146:147], v[18:19], v[68:69], v[146:147] op_sel_hi:[1,0,1]
    v_pk_fma_f32 v[148:149], v[92:93], v[68:69], v[148:149] op_sel_hi:[1,0,1]
    v_pk_fma_f32 v[150:151], v[94:95], v[68:69], v[150:151] op_sel_hi:[1,0,1]
    v_pk_mul_f32 v[140:141], v[140:141], v[74:75]
    v_pk_mul_f32 v[142:143], v[142:143], v[76:77]
    v_pk_mul_f32 v[144:145], v[144:145], v[20:21]
    v_pk_mul_f32 v[146:147], v[146:147], v[22:23]
    v_pk_mul_f32 v[148:149], v[148:149], v[96:97]
    v_pk_mul_f32 v[150:151], v[150:151], v[98:99]
    v_mfma_f32_16x16x16_bf16 v[120:123], v[104:105], v[80:81], v[44:47]
    v_mfma_f32_16x16x16_bf16 v[60:63], v[104:105], v[82:83], v[36:39]
    v_mfma_f32_16x16x16_bf16 v[64:67], v[106:107], v[82:83], v[40:43]
    v_cvt_pk_bf16_f32 v136, v140, v141
    v_cvt_pk_bf16_f32 v137, v142, v143
    s_add_u32 m0, s40, 53504
    s_nop 0
    buffer_load_dwordx4 v25, s[16:19], s43 offen lds
    v_cvt_pk_bf16_f32 v138, v144, v145
    v_cvt_pk_bf16_f32 v139, v146, v147
    v_cvt_pk_bf16_f32 v140, v148, v149
    v_cvt_pk_bf16_f32 v141, v150, v151
    v_max3_f32 v33, v60, v61, v62
    v_max3_f32 v32, v120, v121, v122
    v_max3_f32 v33, v33, v63, v64
    v_max_f32 v32, v32, v123
    v_max3_f32 v33, v33, v65, v66
    v_max_f32 v33, v33, v67
    s_nop 1
    v_permlane32_swap_b32 v32, v33
    v_mov_b32 v72, s62
    v_mov_b32 v73, s62
    v_max_f32 v32, v32, v33
    buffer_load_dwordx4 v11, s[16:19], s43 offen offset:2048 lds
    v_mov_b32 v74, s62
    v_mov_b32 v75, s62
    v_mov_b32 v33, v32
    v_mov_b32 v100, 0
    v_mov_b32 v101, 0
    v_permlane16_swap_b32 v32, v33
    v_mov_b32 v128, 0
    v_mov_b32 v129, 0
    v_max_f32 v32, v32, v33
    v_mov_b32 v33, v32
    s_nop 1
    v_permlane32_swap_b32 v32, v33
    v_mfma_f32_16x16x16_bf16 v[144:147], v[106:107], v[84:85], v[36:39]
    v_mfma_f32_16x16x16_bf16 v[148:151], v[108:109], v[84:85], v[40:43]
    v_mfma_f32_16x16x16_bf16 v[92:95], v[108:109], v[86:87], v[36:39]
    v_mfma_f32_16x16x16_bf16 v[96:99], v[110:111], v[86:87], v[40:43]
    v_mul_f32 v34, -v50, v33
    v_mul_f32 v32, -v48, v32
    v_pk_fma_f32 v[120:121], v[120:121], v[48:49], v[32:33] op_sel_hi:[1,0,0]
    s_add_u32 s43, s43, 32768
    s_add_u32 m0, s40, 57600
    s_nop 0
    buffer_load_dwordx4 v25, s[16:19], s43 offen lds
    v_pk_fma_f32 v[122:123], v[122:123], v[48:49], v[32:33] op_sel_hi:[1,0,0]
    v_pk_fma_f32 v[60:61], v[60:61], v[50:51], v[34:35] op_sel_hi:[1,0,0]
    v_pk_fma_f32 v[62:63], v[62:63], v[50:51], v[34:35] op_sel_hi:[1,0,0]
    v_pk_fma_f32 v[64:65], v[64:65], v[50:51], v[34:35] op_sel_hi:[1,0,0]
    v_pk_fma_f32 v[66:67], v[66:67], v[50:51], v[34:35] op_sel_hi:[1,0,0]
    v_exp_f32 v120, v120
    v_exp_f32 v121, v121
    v_exp_f32 v122, v122
    v_exp_f32 v123, v123
    v_cvt_pk_bf16_f32 v102, v120, v121
    v_cvt_pk_bf16_f32 v103, v122, v123
    s_nop 1
    v_mfma_f32_16x16x32_bf16 v[156:159], v[72:75], v[100:103], 0
    v_mfma_f32_16x16x32_bf16 v[152:155], v[128:131], v[100:103], 0
    v_exp_f32 v60, v60
    buffer_load_dwordx4 v11, s[16:19], s43 offen offset:2048 lds
    v_exp_f32 v61, v61
    v_exp_f32 v62, v62
    v_exp_f32 v63, v63
    v_exp_f32 v64, v64
    v_exp_f32 v65, v65
    v_exp_f32 v66, v66
    v_exp_f32 v67, v67
    v_cvt_pk_bf16_f32 v124, v60, v61
    v_cvt_pk_bf16_f32 v125, v62, v63
    v_cvt_pk_bf16_f32 v126, v64, v65
    v_cvt_pk_bf16_f32 v127, v66, v67
    s_nop 1
    v_mfma_f32_16x16x32_bf16 v[20:23], v[72:75], v[124:127], 0
    v_mfma_f32_16x16x32_bf16 v[16:19], v[130:133], v[124:127], 0
    v_max3_f32 v3, v92, v93, v94
    s_add_u32 s43, s43, 32768
    s_add_u32 m0, s40, 61696
    s_nop 0
    buffer_load_dwordx4 v25, s[16:19], s43 offen lds
    v_max3_f32 v2, v144, v145, v146
    v_max3_f32 v3, v3, v95, v96
    v_max3_f32 v2, v2, v147, v148
    v_max3_f32 v3, v3, v97, v98
    v_max3_f32 v2, v2, v149, v150
    v_max_f32 v3, v3, v99
    v_max_f32 v2, v2, v151
    s_nop 1
    v_permlane32_swap_b32 v2, v3
    v_rcp_f32 v156, v156
    v_rcp_f32 v20, v20
    v_max_f32 v2, v2, v3
    v_pk_mul_f32 v[152:153], v[152:153], v[156:157] op_sel_hi:[1,0]
    v_pk_mul_f32 v[154:155], v[154:155], v[156:157] op_sel_hi:[1,0]
    v_mov_b32 v3, v2
    buffer_load_dwordx4 v11, s[16:19], s43 offen offset:2048 lds
    v_pk_mul_f32 v[16:17], v[16:17], v[20:21] op_sel_hi:[1,0]
    v_pk_mul_f32 v[18:19], v[18:19], v[20:21] op_sel_hi:[1,0]
    v_permlane16_swap_b32 v2, v3
    v_cvt_pk_bf16_f32 v76, v152, v153
    v_cvt_pk_bf16_f32 v77, v154, v155
    v_max_f32 v2, v2, v3
    v_cvt_pk_bf16_f32 v78, v16, v17
    v_cvt_pk_bf16_f32 v79, v18, v19
    v_mov_b32 v3, v2
    s_nop 1
    v_permlane32_swap_b32 v2, v3
    v_permlane32_swap_b32 v76, v78
    v_permlane32_swap_b32 v77, v79
    buffer_store_dwordx4 v[76:79], v8, s[12:15], s39 offen sc1
    v_mfma_f32_16x16x16_bf16 v[116:119], v[110:111], v[88:89], v[36:39]
    v_mfma_f32_16x16x16_bf16 v[120:123], v[112:113], v[88:89], v[40:43]
    v_mfma_f32_16x16x16_bf16 v[60:63], v[112:113], v[90:91], v[36:39]
    v_mfma_f32_16x16x16_bf16 v[64:67], v[114:115], v[90:91], v[40:43]
    v_mul_f32 v24, -v54, v3
    v_mul_f32 v2, -v52, v2
    s_add_u32 s43, s43, 32768
    s_add_u32 m0, s40, 107008
    s_nop 0
    buffer_load_dwordx4 v25, s[16:19], s43 offen lds
    v_pk_fma_f32 v[144:145], v[144:145], v[52:53], v[2:3] op_sel_hi:[1,0,0]
    v_pk_fma_f32 v[146:147], v[146:147], v[52:53], v[2:3] op_sel_hi:[1,0,0]
    v_pk_fma_f32 v[148:149], v[148:149], v[52:53], v[2:3] op_sel_hi:[1,0,0]
    v_pk_fma_f32 v[150:151], v[150:151], v[52:53], v[2:3] op_sel_hi:[1,0,0]
    v_pk_fma_f32 v[92:93], v[92:93], v[54:55], v[24:25] op_sel_hi:[1,0,0]
    v_pk_fma_f32 v[94:95], v[94:95], v[54:55], v[24:25] op_sel_hi:[1,0,0]
    v_pk_fma_f32 v[96:97], v[96:97], v[54:55], v[24:25] op_sel_hi:[1,0,0]
    v_pk_fma_f32 v[98:99], v[98:99], v[54:55], v[24:25] op_sel_hi:[1,0,0]
    v_exp_f32 v144, v144
    v_exp_f32 v145, v145
    v_exp_f32 v146, v146
    v_exp_f32 v147, v147
    v_exp_f32 v148, v148
    v_exp_f32 v149, v149
    buffer_load_dwordx4 v11, s[16:19], s43 offen offset:2048 lds
    v_exp_f32 v150, v150
    v_exp_f32 v151, v151
    v_cvt_pk_bf16_f32 v100, v144, v145
    v_cvt_pk_bf16_f32 v101, v146, v147
    v_cvt_pk_bf16_f32 v102, v148, v149
    v_cvt_pk_bf16_f32 v103, v150, v151
    s_nop 1
    v_mfma_f32_16x16x32_bf16 v[156:159], v[72:75], v[100:103], 0
    v_mfma_f32_16x16x32_bf16 v[152:155], v[132:135], v[100:103], 0
    v_exp_f32 v92, v92
    v_exp_f32 v93, v93
    v_exp_f32 v94, v94
    v_exp_f32 v95, v95
    v_exp_f32 v96, v96
    v_exp_f32 v97, v97
    s_add_u32 s43, s43, 32768
    s_add_u32 m0, s40, 111104
    s_nop 0
    buffer_load_dwordx4 v25, s[16:19], s43 offen lds
    v_exp_f32 v98, v98
    v_exp_f32 v99, v99
    v_cvt_pk_bf16_f32 v124, v92, v93
    v_cvt_pk_bf16_f32 v125, v94, v95
    v_cvt_pk_bf16_f32 v126, v96, v97
    v_cvt_pk_bf16_f32 v127, v98, v99
    s_nop 1
    v_mfma_f32_16x16x32_bf16 v[20:23], v[72:75], v[124:127], 0
    v_mfma_f32_16x16x32_bf16 v[16:19], v[134:137], v[124:127], 0
    v_max3_f32 v33, v60, v61, v62
    v_max3_f32 v32, v116, v117, v118
    v_max3_f32 v33, v33, v63, v64
    v_max3_f32 v32, v32, v119, v120
    v_max3_f32 v33, v33, v65, v66
    v_max3_f32 v32, v32, v121, v122
    buffer_load_dwordx4 v11, s[16:19], s43 offen offset:2048 lds
    v_max_f32 v33, v33, v67
    v_max_f32 v32, v32, v123
    s_nop 1
    v_permlane32_swap_b32 v32, v33
    v_rcp_f32 v156, v156
    v_rcp_f32 v20, v20
    v_max_f32 v32, v32, v33
    v_pk_mul_f32 v[152:153], v[152:153], v[156:157] op_sel_hi:[1,0]
    v_pk_mul_f32 v[154:155], v[154:155], v[156:157] op_sel_hi:[1,0]
    v_mov_b32 v33, v32
    v_pk_mul_f32 v[16:17], v[16:17], v[20:21] op_sel_hi:[1,0]
    v_pk_mul_f32 v[18:19], v[18:19], v[20:21] op_sel_hi:[1,0]
    v_permlane16_swap_b32 v32, v33
    v_cvt_pk_bf16_f32 v76, v152, v153
    v_cvt_pk_bf16_f32 v77, v154, v155
    s_add_u32 s43, s43, 32768
    s_add_u32 m0, s40, 115200
    s_nop 0
    buffer_load_dwordx4 v25, s[16:19], s43 offen lds
    v_max_f32 v32, v32, v33
    v_cvt_pk_bf16_f32 v78, v16, v17
    v_cvt_pk_bf16_f32 v79, v18, v19
    v_mov_b32 v33, v32
    s_nop 1
    v_permlane32_swap_b32 v32, v33
    v_permlane32_swap_b32 v76, v78
    v_permlane32_swap_b32 v77, v79
    buffer_store_dwordx4 v[76:79], v9, s[12:15], s39 offen sc1
    v_mul_f32 v34, -v58, v33
    v_mul_f32 v32, -v56, v32
    v_pk_fma_f32 v[116:117], v[116:117], v[56:57], v[32:33] op_sel_hi:[1,0,0]
    v_pk_fma_f32 v[118:119], v[118:119], v[56:57], v[32:33] op_sel_hi:[1,0,0]
    v_pk_fma_f32 v[120:121], v[120:121], v[56:57], v[32:33] op_sel_hi:[1,0,0]
    v_pk_fma_f32 v[122:123], v[122:123], v[56:57], v[32:33] op_sel_hi:[1,0,0]
    v_pk_fma_f32 v[60:61], v[60:61], v[58:59], v[34:35] op_sel_hi:[1,0,0]
    buffer_load_dwordx4 v11, s[16:19], s43 offen offset:2048 lds
    v_pk_fma_f32 v[62:63], v[62:63], v[58:59], v[34:35] op_sel_hi:[1,0,0]
    v_pk_fma_f32 v[64:65], v[64:65], v[58:59], v[34:35] op_sel_hi:[1,0,0]
    v_pk_fma_f32 v[66:67], v[66:67], v[58:59], v[34:35] op_sel_hi:[1,0,0]
    v_exp_f32 v116, v116
    v_exp_f32 v117, v117
    v_exp_f32 v118, v118
    v_exp_f32 v119, v119
    v_exp_f32 v120, v120
    v_exp_f32 v121, v121
    v_exp_f32 v122, v122
    v_exp_f32 v123, v123
    v_cvt_pk_bf16_f32 v100, v116, v117
    v_cvt_pk_bf16_f32 v101, v118, v119
    v_cvt_pk_bf16_f32 v102, v120, v121
    v_cvt_pk_bf16_f32 v103, v122, v123
    s_nop 1
    v_mfma_f32_16x16x32_bf16 v[156:159], v[72:75], v[100:103], 0
    v_mfma_f32_16x16x32_bf16 v[152:155], v[136:139], v[100:103], 0
    v_exp_f32 v60, v60
    v_exp_f32 v61, v61
    v_exp_f32 v62, v62
    v_exp_f32 v63, v63
    v_exp_f32 v64, v64
    v_exp_f32 v65, v65
    v_exp_f32 v66, v66
    v_exp_f32 v67, v67
    v_cvt_pk_bf16_f32 v124, v60, v61
    v_cvt_pk_bf16_f32 v125, v62, v63
    v_cvt_pk_bf16_f32 v126, v64, v65
    v_cvt_pk_bf16_f32 v127, v66, v67
    s_nop 1
    v_mfma_f32_16x16x32_bf16 v[20:23], v[72:75], v[124:127], 0
    v_mfma_f32_16x16x32_bf16 v[16:19], v[138:141], v[124:127], 0
    v_rcp_f32 v156, v156
    s_nop 5
    v_rcp_f32 v20, v20
    v_pk_mul_f32 v[152:153], v[152:153], v[156:157] op_sel_hi:[1,0]
    v_pk_mul_f32 v[154:155], v[154:155], v[156:157] op_sel_hi:[1,0]
    v_pk_mul_f32 v[16:17], v[16:17], v[20:21] op_sel_hi:[1,0]
    v_pk_mul_f32 v[18:19], v[18:19], v[20:21] op_sel_hi:[1,0]
    v_cvt_pk_bf16_f32 v76, v152, v153
    v_cvt_pk_bf16_f32 v77, v154, v155
    v_cvt_pk_bf16_f32 v78, v16, v17
    v_cvt_pk_bf16_f32 v79, v18, v19
    s_nop 0
    v_permlane32_swap_b32 v76, v78
    v_permlane32_swap_b32 v77, v79
    buffer_store_dwordx4 v[76:79], v13, s[12:15], s39 offen sc1
L_phase2:
    v_xor_b32 v5, 64, v4
    ds_read_b64_tr_b16 a[48:49], v4 offset:0
    ds_read_b64_tr_b16 a[50:51], v4 offset:1024
    ds_read_b64_tr_b16 a[52:53], v5 offset:0
    ds_read_b64_tr_b16 a[54:55], v5 offset:1024
    ds_read_b64_tr_b16 a[56:57], v4 offset:2048
    ds_read_b64_tr_b16 a[58:59], v4 offset:3072
    ds_read_b64_tr_b16 a[60:61], v5 offset:2048
    ds_read_b64_tr_b16 a[62:63], v5 offset:3072
    ds_read_b64_tr_b16 a[64:65], v4 offset:4096
    ds_read_b64_tr_b16 a[66:67], v4 offset:5120
    ds_read_b64_tr_b16 a[68:69], v5 offset:4096
    ds_read_b64_tr_b16 a[70:71], v5 offset:5120
    ds_read_b64_tr_b16 a[72:73], v4 offset:6144
    ds_read_b64_tr_b16 a[74:75], v4 offset:7168
    ds_read_b64_tr_b16 a[76:77], v5 offset:6144
    ds_read_b64_tr_b16 a[78:79], v5 offset:7168
    ds_read_b64_tr_b16 a[80:81], v4 offset:8192
    ds_read_b64_tr_b16 a[82:83], v4 offset:9216
    ds_read_b64_tr_b16 a[84:85], v5 offset:8192
    ds_read_b64_tr_b16 a[86:87], v5 offset:9216
    ds_read_b64_tr_b16 a[88:89], v4 offset:10240
    ds_read_b64_tr_b16 a[90:91], v4 offset:11264
    ds_read_b64_tr_b16 a[92:93], v5 offset:10240
    ds_read_b64_tr_b16 a[94:95], v5 offset:11264
    v_and_b32 v1, 31, v0
    v_lshrrev_b32 v2, 5, v0
    s_lshl_b32 s71, s64, 6
    s_add_u32 s71, s71, s73
    s_lshl_b32 s71, s71, 10
    s_lshl_b32 s72, s65, 7
    s_add_u32 s71, s71, s72
    s_lshl_b32 s72, s52, 14
    s_add_u32 s71, s71, s72
    v_lshrrev_b32 v18, 3, v0
    v_and_b32 v19, 7, v0
    v_lshlrev_b32 v13, 11, v18
    v_lshl_add_u32 v13, v19, 4, v13
    v_add_u32 v13, s71, v13
    s_mul_i32 s72, s73, 6144
    s_mul_i32 s78, s52, 1152
    s_add_u32 s78, s78, s72
    s_add_u32 s78, s78, 53504
    v_mul_u32_u24 v18, 144, v18
    v_and_b32 v20, 3, v19
    v_lshl_add_u32 v18, v20, 5, v18
    v_lshrrev_b32 v19, 2, v19
    v_mul_u32_u24 v19, 53520, v19
    v_add3_u32 v18, v18, v19, s78
    s_add_u32 s72, s72, s1
    s_add_u32 s72, s72, 53504
    v_mul_u32_u24 v14, 144, v1
    v_lshl_add_u32 v14, v2, 4, v14
    v_add_u32 v14, s72, v14
    s_lshl_b32 s71, s64, 1
    s_add_u32 s71, s71, s73
    s_mul_i32 s54, s71, 120832
    s_sub_u32 s70, s52, 1
    s_mul_i32 s72, s70, 29696
    s_cmp_eq_u32 s52, 0
    s_cselect_b32 s72, 88064, s72
    s_add_u32 s54, s54, s72
    s_add_u32 s55, s54, 28672
    s_cmp_eq_u32 s52, 0
    s_cselect_b32 s77, s55, 2147483648
    s_cmp_eq_u32 s52, 3
    s_cselect_b32 s55, 2147483648, s55
    s_lshr_b32 s71, s64, 1
    s_lshl_b32 s71, s71, 7
    v_min_u32 v3, 9, v0
    v_lshl_add_u32 v12, v3, 2, s71
    s_lshl_b32 s72, s64, 6
    s_mul_i32 s78, s72, 745
    s_lshr_b32 s78, s78, 17
    s_add_u32 s72, s72, 63
    s_mul_i32 s72, s72, 745
    s_lshr_b32 s72, s72, 17
    s_sub_u32 s72, s72, s78
    s_lshl_b32 s72, s72, 7
    s_lshl_b32 s78, s78, 7
    s_add_u32 s78, s78, 8192
    v_mul_u32_u24 v2, s72, v2
    v_and_b32 v1, 7, v0
    v_lshl_add_u32 v1, v1, 2, s78
    v_add_u32 v1, v1, v2
    s_cmp_eq_u32 s52, 0
    s_cselect_b64 vcc, -1, 0
    v_cndmask_b32 v12, v12, v1, vcc
    s_lshl_b32 s69, s3, 2
    s_add_u32 s69, s69, 163792
    v_mov_b32 v15, s69
    v_xor_b32 v16, 4, v15
    v_mov_b32 v2, s68
    s_waitcnt vmcnt(0) lgkmcnt(0)
    s_barrier
    s_cmp_lg_u32 s3, 0
    s_cbranch_scc1 L_noflag
    s_mov_b64 exec, 1
    buffer_store_dword v2, off, s[80:83], s75 sc1
    s_mov_b64 exec, -1
L_noflag:
    v_add_u32 v8, s41, v10
    v_xor_b32 v9, 64, v8
    v_add_u32 v4, 53504, v4
    v_add_u32 v5, 53504, v5
    s_cmp_gt_u32 s74, 1
    s_cbranch_scc1 L_had1
    s_add_u32 s43, s43, 32768
    s_add_u32 m0, s40, 107008
    s_nop 0
    buffer_load_dwordx4 v25, s[16:19], s43 offen lds
    buffer_load_dwordx4 v11, s[16:19], s43 offen offset:2048 lds
    s_add_u32 s43, s43, 32768
    s_add_u32 m0, s40, 111104
    s_nop 0
    buffer_load_dwordx4 v25, s[16:19], s43 offen lds
    buffer_load_dwordx4 v11, s[16:19], s43 offen offset:2048 lds
    s_add_u32 s43, s43, 32768
    s_add_u32 m0, s40, 115200
    s_nop 0
    buffer_load_dwordx4 v25, s[16:19], s43 offen lds
    buffer_load_dwordx4 v11, s[16:19], s43 offen offset:2048 lds
L_had1:
    s_add_u32 s43, s43, 32768
    s_add_u32 m0, s42, 0
    s_nop 0
    buffer_load_dwordx4 v25, s[16:19], s43 offen lds
    buffer_load_dwordx4 v11, s[16:19], s43 offen offset:2048 lds
    s_add_u32 s43, s43, 32768
    s_add_u32 m0, s42, 4096
    s_nop 0
    buffer_load_dwordx4 v25, s[16:19], s43 offen lds
    buffer_load_dwordx4 v11, s[16:19], s43 offen offset:2048 lds
    s_cmp_eq_u32 s52, 3
    s_cbranch_scc1 L_sdonep
    s_add_u32 s43, s43, 32768
    s_add_u32 m0, s42, 8192
    s_nop 0
    buffer_load_dwordx4 v25, s[16:19], s43 offen lds
    s_cmp_lg_u32 s52, 0
    s_cbranch_scc1 L_sdonep
    buffer_load_dwordx4 v11, s[16:19], s43 offen offset:2048 lds
    s_add_u32 s43, s43, 32768
    s_add_u32 m0, s42, 12288
    s_nop 0
    buffer_load_dwordx4 v25, s[16:19], s43 offen lds
    buffer_load_dwordx4 v11, s[16:19], s43 offen offset:2048 lds
L_sdonep:
    s_min_u32 s70, s52, 1
    s_lshl_b32 s70, s70, 2
    s_add_u32 s70, s70, 163824
    v_mov_b32 v1, s70
    s_mov_b32 s69, 0
    s_and_b32 s71, s3, 5
    s_cmp_lg_u32 s71, 0
    s_cbranch_scc0 L_poller
    s_waitcnt vmcnt(0)
    s_barrier
    s_branch L_lpoll
L_poller:
    s_waitcnt vmcnt(0)
    s_barrier
L_poll:
    buffer_load_dword v3, v12, s[80:83], 0 offen sc1
L_pchk:
    s_add_u32 s69, s69, 1
    s_waitcnt vmcnt(0)
    v_cmp_ne_u32 vcc, s68, v3
    s_nop 3
    s_cbranch_vccz L_ptell
    s_sleep 1
    s_cmp_lt_u32 s69, 262144
    s_cbranch_scc1 L_poll
L_ptell:
    ds_write_b32 v1, v2
    s_branch L_pollok
L_lpoll:
    ds_read_b32 v3, v1
    s_add_u32 s69, s69, 1
    s_waitcnt lgkmcnt(0)
    v_cmp_ne_u32 vcc, s68, v3
    s_nop 3
    s_cbranch_vccz L_pollok
    s_sleep 1
    s_cmp_lt_u32 s69, 2097152
    s_cbranch_scc1 L_lpoll
L_pollok:
    buffer_load_dwordx4 v[80:83], v29, s[12:15], s54 offen sc1
    buffer_load_dwordx4 v[84:87], v29, s[12:15], s54 offen offset:1024 sc1
    buffer_load_dwordx4 v[88:91], v29, s[12:15], s54 offen offset:2048 sc1
    buffer_load_dwordx4 v[92:95], v29, s[12:15], s54 offen offset:3072 sc1
    s_add_u32 s54, s54, 4096
    buffer_load_dwordx4 v[96:99], v29, s[12:15], s54 offen sc1
    buffer_load_dwordx4 v[100:103], v29, s[12:15], s54 offen offset:1024 sc1
    s_waitcnt vmcnt(5)
    v_mfma_f32_32x32x16_bf16 v[128:143], a[0:3], v[80:83], 0
    buffer_load_dwordx4 v[104:107], v29, s[12:15], s54 offen offset:2048 sc1
    v_mfma_f32_32x32x16_bf16 v[144:159], a[4:7], v[80:83], 0
    s_waitcnt vmcnt(5)
    v_mfma_f32_32x32x16_bf16 v[128:143], a[8:11], v[84:87], v[128:143]
    buffer_load_dwordx4 v[108:111], v29, s[12:15], s54 offen offset:3072 sc1
    v_mfma_f32_32x32x16_bf16 v[144:159], a[12:15], v[84:87], v[144:159]
    s_waitcnt vmcnt(5)
    v_mfma_f32_32x32x16_bf16 v[128:143], a[16:19], v[88:91], v[128:143]
    s_add_u32 s54, s54, 4096
    buffer_load_dwordx4 v[112:115], v29, s[12:15], s54 offen sc1
    v_mfma_f32_32x32x16_bf16 v[144:159], a[20:23], v[88:91], v[144:159]
    s_waitcnt vmcnt(5)
    v_mfma_f32_32x32x16_bf16 v[128:143], a[24:27], v[92:95], v[128:143]
    buffer_load_dwordx4 v[116:119], v29, s[12:15], s54 offen offset:1024 sc1
    v_mfma_f32_32x32x16_bf16 v[144:159], a[28:31], v[92:95], v[144:159]
    s_waitcnt vmcnt(5)
    v_mfma_f32_32x32x16_bf16 v[128:143], a[32:35], v[96:99], v[128:143]
    buffer_load_dwordx4 v[120:123], v29, s[12:15], s54 offen offset:2048 sc1
    v_mfma_f32_32x32x16_bf16 v[144:159], a[36:39], v[96:99], v[144:159]
    s_waitcnt vmcnt(5)
    v_mfma_f32_32x32x16_bf16 v[128:143], a[40:43], v[100:103], v[128:143]
    buffer_load_dwordx4 v[124:127], v29, s[12:15], s54 offen offset:3072 sc1
    v_mfma_f32_32x32x16_bf16 v[144:159], a[44:47], v[100:103], v[144:159]
    s_waitcnt vmcnt(5)
    v_mfma_f32_32x32x16_bf16 v[128:143], a[48:51], v[104:107], v[128:143]
    s_add_u32 s54, s54, 4096
    buffer_load_dwordx4 v[80:83], v29, s[12:15], s54 offen sc1
    v_mfma_f32_32x32x16_bf16 v[144:159], a[52:55], v[104:107], v[144:159]
    s_waitcnt vmcnt(5)
    v_mfma_f32_32x32x16_bf16 v[128:143], a[56:59], v[108:111], v[128:143]
    buffer_load_dwordx4 v[84:87], v29, s[12:15], s54 offen offset:1024 sc1
    v_mfma_f32_32x32x16_bf16 v[144:159], a[60:63], v[108:111], v[144:159]
    s_waitcnt vmcnt(5)
    v_mfma_f32_32x32x16_bf16 v[128:143], a[64:67], v[112:115], v[128:143]
    buffer_load_dwordx4 v[88:91], v29, s[12:15], s54 offen offset:2048 sc1
    v_mfma_f32_32x32x16_bf16 v[144:159], a[68:71], v[112:115], v[144:159]
    s_waitcnt vmcnt(5)
    v_mfma_f32_32x32x16_bf16 v[128:143], a[72:75], v[116:119], v[128:143]
    buffer_load_dwordx4 v[92:95], v29, s[12:15], s54 offen offset:3072 sc1
    v_mfma_f32_32x32x16_bf16 v[144:159], a[76:79], v[116:119], v[144:159]
    s_waitcnt vmcnt(5)
    v_mfma_f32_32x32x16_bf16 v[128:143], a[80:83], v[120:123], v[128:143]
    ds_read_b64_tr_b16 v[48:49], v4 offset:0
    ds_read_b64_tr_b16 v[50:51], v4 offset:1024
    s_add_u32 s54, s54, 4096
    buffer_load_dwordx4 v[96:99], v29, s[12:15], s54 offen sc1
    v_mfma_f32_32x32x16_bf16 v[144:159], a[84:87], v[120:123], v[144:159]
    ds_read_b64_tr_b16 v[52:53], v5 offset:0
    ds_read_b64_tr_b16 v[54:55], v5 offset:1024
    s_waitcnt vmcnt(5)
    v_mfma_f32_32x32x16_bf16 v[128:143], a[88:91], v[124:127], v[128:143]
    ds_read_b64_tr_b16 v[56:57], v4 offset:2048
    ds_read_b64_tr_b16 v[58:59], v4 offset:3072
    buffer_load_dwordx4 v[100:103], v29, s[12:15], s54 offen offset:1024 sc1
    v_mfma_f32_32x32x16_bf16 v[144:159], a[92:95], v[124:127], v[144:159]
    ds_read_b64_tr_b16 v[60:61], v5 offset:2048
    ds_read_b64_tr_b16 v[62:63], v5 offset:3072
    s_waitcnt vmcnt(5) lgkmcnt(4)
    v_mfma_f32_32x32x16_bf16 v[128:143], v[48:51], v[80:83], v[128:143]
    ds_read_b64_tr_b16 v[64:65], v4 offset:4096
    ds_read_b64_tr_b16 v[66:67], v4 offset:5120
    buffer_load_dwordx4 v[104:107], v29, s[12:15], s54 offen offset:2048 sc1
    v_mfma_f32_32x32x16_bf16 v[144:159], v[52:55], v[80:83], v[144:159]
    ds_read_b64_tr_b16 v[68:69], v5 offset:4096
    ds_read_b64_tr_b16 v[70:71], v5 offset:5120
    s_waitcnt vmcnt(5) lgkmcnt(4)
    v_mfma_f32_32x32x16_bf16 v[128:143], v[56:59], v[84:87], v[128:143]
    ds_read_b64_tr_b16 v[72:73], v4 offset:6144
    ds_read_b64_tr_b16 v[74:75], v4 offset:7168
    buffer_load_dwordx4 v[108:111], v29, s[12:15], s54 offen offset:3072 sc1
    v_mfma_f32_32x32x16_bf16 v[144:159], v[60:63], v[84:87], v[144:159]
    ds_read_b64_tr_b16 v[76:77], v5 offset:6144
    ds_read_b64_tr_b16 v[78:79], v5 offset:7168
    s_waitcnt vmcnt(5) lgkmcnt(4)
    v_mfma_f32_32x32x16_bf16 v[128:143], v[64:67], v[88:91], v[128:143]
    ds_read_b64_tr_b16 v[48:49], v4 offset:8192
    ds_read_b64_tr_b16 v[50:51], v4 offset:9216
    s_add_u32 s54, s54, 4096
    buffer_load_dwordx4 v[112:115], v29, s[12:15], s54 offen sc1
    v_mfma_f32_32x32x16_bf16 v[144:159], v[68:71], v[88:91], v[144:159]
    ds_read_b64_tr_b16 v[52:53], v5 offset:8192
    ds_read_b64_tr_b16 v[54:55], v5 offset:9216
    s_waitcnt vmcnt(5) lgkmcnt(4)
    v_mfma_f32_32x32x16_bf16 v[128:143], v[72:75], v[92:95], v[128:143]
    ds_read_b64_tr_b16 v[56:57], v4 offset:10240
    ds_read_b64_tr_b16 v[58:59], v4 offset:11264
    buffer_load_dwordx4 v[116:119], v29, s[12:15], s54 offen offset:1024 sc1
    v_mfma_f32_32x32x16_bf16 v[144:159], v[76:79], v[92:95], v[144:159]
    ds_read_b64_tr_b16 v[60:61], v5 offset:10240
    ds_read_b64_tr_b16 v[62:63], v5 offset:11264
    s_waitcnt vmcnt(5) lgkmcnt(4)
    v_mfma_f32_32x32x16_bf16 v[128:143], v[48:51], v[96:99], v[128:143]
    ds_read_b64_tr_b16 v[64:65], v6 offset:0
    ds_read_b64_tr_b16 v[66:67], v6 offset:1024
    buffer_load_dwordx4 v[120:123], v29, s[12:15], s54 offen offset:2048 sc1
    v_mfma_f32_32x32x16_bf16 v[144:159], v[52:55], v[96:99], v[144:159]
    ds_read_b64_tr_b16 v[68:69], v7 offset:0
    ds_read_b64_tr_b16 v[70:71], v7 offset:1024
    s_waitcnt vmcnt(5) lgkmcnt(4)
    v_mfma_f32_32x32x16_bf16 v[128:143], v[56:59], v[100:103], v[128:143]
    ds_read_b64_tr_b16 v[72:73], v6 offset:2048
    ds_read_b64_tr_b16 v[74:75], v6 offset:3072
    buffer_load_dwordx4 v[124:127], v29, s[12:15], s54 offen offset:3072 sc1
    v_mfma_f32_32x32x16_bf16 v[144:159], v[60:63], v[100:103], v[144:159]
    ds_read_b64_tr_b16 v[76:77], v7 offset:2048
    ds_read_b64_tr_b16 v[78:79], v7 offset:3072
    s_waitcnt vmcnt(5) lgkmcnt(4)
    v_mfma_f32_32x32x16_bf16 v[128:143], v[64:67], v[104:107], v[128:143]
    ds_read_b64_tr_b16 v[48:49], v6 offset:4096
    ds_read_b64_tr_b16 v[50:51], v6 offset:5120
    s_add_u32 s54, s54, 4096
    buffer_load_dwordx4 v[80:83], v29, s[12:15], s54 offen sc1
    v_mfma_f32_32x32x16_bf16 v[144:159], v[68:71], v[104:107], v[144:159]
    ds_read_b64_tr_b16 v[52:53], v7 offset:4096
    ds_read_b64_tr_b16 v[54:55], v7 offset:5120
    s_waitcnt vmcnt(5) lgkmcnt(4)
    v_mfma_f32_32x32x16_bf16 v[128:143], v[72:75], v[108:111], v[128:143]
    ds_read_b64_tr_b16 v[56:57], v6 offset:6144
    ds_read_b64_tr_b16 v[58:59], v6 offset:7168
    buffer_load_dwordx4 v[84:87], v29, s[12:15], s54 offen offset:1024 sc1
    v_mfma_f32_32x32x16_bf16 v[144:159], v[76:79], v[108:111], v[144:159]
    ds_read_b64_tr_b16 v[60:61], v7 offset:6144
    ds_read_b64_tr_b16 v[62:63], v7 offset:7168
    s_waitcnt vmcnt(5) lgkmcnt(4)
    v_mfma_f32_32x32x16_bf16 v[128:143], v[48:51], v[112:115], v[128:143]
    ds_read_b64_tr_b16 v[64:65], v6 offset:8192
    ds_read_b64_tr_b16 v[66:67], v6 offset:9216
    buffer_load_dwordx4 v[88:91], v29, s[12:15], s54 offen offset:2048 sc1
    v_mfma_f32_32x32x16_bf16 v[144:159], v[52:55], v[112:115], v[144:159]
    ds_read_b64_tr_b16 v[68:69], v7 offset:8192
    ds_read_b64_tr_b16 v[70:71], v7 offset:9216
    s_waitcnt vmcnt(5) lgkmcnt(4)
    v_mfma_f32_32x32x16_bf16 v[128:143], v[56:59], v[116:119], v[128:143]
    ds_read_b64_tr_b16 v[72:73], v6 offset:10240
    ds_read_b64_tr_b16 v[74:75], v6 offset:11264
    buffer_load_dwordx4 v[92:95], v29, s[12:15], s54 offen offset:3072 sc1
    v_mfma_f32_32x32x16_bf16 v[144:159], v[60:63], v[116:119], v[144:159]
    ds_read_b64_tr_b16 v[76:77], v7 offset:10240
    ds_read_b64_tr_b16 v[78:79], v7 offset:11264
    s_waitcnt vmcnt(5) lgkmcnt(4)
    v_mfma_f32_32x32x16_bf16 v[128:143], v[64:67], v[120:123], v[128:143]
    ds_read_b64_tr_b16 v[48:49], v8 offset:0
    ds_read_b64_tr_b16 v[50:51], v8 offset:1024
    buffer_load_dwordx4 v[96:99], v29, s[12:15], s55 offen sc1
    v_mfma_f32_32x32x16_bf16 v[144:159], v[68:71], v[120:123], v[144:159]
    ds_read_b64_tr_b16 v[52:53], v9 offset:0
    ds_read_b64_tr_b16 v[54:55], v9 offset:1024
    s_waitcnt vmcnt(5) lgkmcnt(4)
    v_mfma_f32_32x32x16_bf16 v[128:143], v[72:75], v[124:127], v[128:143]
    ds_read_b64_tr_b16 v[56:57], v8 offset:2048
    ds_read_b64_tr_b16 v[58:59], v8 offset:3072
    buffer_load_dwordx4 v[100:103], v29, s[12:15], s77 offen offset:1024 sc1
    v_mfma_f32_32x32x16_bf16 v[144:159], v[76:79], v[124:127], v[144:159]
    ds_read_b64_tr_b16 v[60:61], v9 offset:2048
    ds_read_b64_tr_b16 v[62:63], v9 offset:3072
    s_waitcnt vmcnt(5) lgkmcnt(4)
    ds_write_b32 v15, v2
    v_mfma_f32_32x32x16_bf16 v[128:143], v[48:51], v[80:83], v[128:143]
    ds_read_b64_tr_b16 v[64:65], v8 offset:4096
    ds_read_b64_tr_b16 v[66:67], v8 offset:5120
    buffer_load_dwordx4 v[104:107], v29, s[12:15], s77 offen offset:2048 sc1
    v_mfma_f32_32x32x16_bf16 v[144:159], v[52:55], v[80:83], v[144:159]
    ds_read_b64_tr_b16 v[68:69], v9 offset:4096
    ds_read_b64_tr_b16 v[70:71], v9 offset:5120
    s_waitcnt vmcnt(5) lgkmcnt(5)
    v_mfma_f32_32x32x16_bf16 v[128:143], v[56:59], v[84:87], v[128:143]
    ds_read_b64_tr_b16 v[72:73], v8 offset:6144
    ds_read_b64_tr_b16 v[74:75], v8 offset:7168
    buffer_load_dwordx4 v[108:111], v29, s[12:15], s77 offen offset:3072 sc1
    v_mfma_f32_32x32x16_bf16 v[144:159], v[60:63], v[84:87], v[144:159]
    ds_read_b64_tr_b16 v[76:77], v9 offset:6144
    ds_read_b64_tr_b16 v[78:79], v9 offset:7168
    buffer_load_dwordx4 v[44:47], v13, s[20:23], 0 offen
    s_waitcnt vmcnt(6) lgkmcnt(4)
    ds_read_b32 v3, v16
    v_mfma_f32_32x32x16_bf16 v[128:143], v[64:67], v[88:91], v[128:143]
    ds_read_b64_tr_b16 v[48:49], v8 offset:8192
    ds_read_b64_tr_b16 v[50:51], v8 offset:9216
    v_mfma_f32_32x32x16_bf16 v[144:159], v[68:71], v[88:91], v[144:159]
    ds_read_b64_tr_b16 v[52:53], v9 offset:8192
    ds_read_b64_tr_b16 v[54:55], v9 offset:9216
    s_waitcnt vmcnt(5) lgkmcnt(4)
    v_cmp_ne_u32 vcc, s68, v3
    s_mov_b32 s70, 3216550459
    s_mov_b32 s71, 3216550459
    v_mfma_f32_32x32x16_bf16 v[128:143], v[72:75], v[92:95], v[128:143]
    ds_read_b64_tr_b16 v[56:57], v8 offset:10240
    ds_read_b64_tr_b16 v[58:59], v8 offset:11264
    v_mfma_f32_32x32x16_bf16 v[144:159], v[76:79], v[92:95], v[144:159]
    ds_read_b64_tr_b16 v[60:61], v9 offset:10240
    ds_read_b64_tr_b16 v[62:63], v9 offset:11264
    s_cmp_eq_u32 s52, 3
    s_cbranch_scc1 L_p2done
    s_waitcnt vmcnt(4) lgkmcnt(4)
    v_mfma_f32_32x32x16_bf16 v[128:143], v[48:51], v[96:99], v[128:143]
    ds_read_b64_tr_b16 v[64:65], v8 offset:12288
    ds_read_b64_tr_b16 v[66:67], v8 offset:13312
    v_mfma_f32_32x32x16_bf16 v[144:159], v[52:55], v[96:99], v[144:159]
    ds_read_b64_tr_b16 v[68:69], v9 offset:12288
    ds_read_b64_tr_b16 v[70:71], v9 offset:13312
    s_cmp_lg_u32 s52, 0
    s_cbranch_scc1 L_p2done
    s_waitcnt vmcnt(3) lgkmcnt(4)
    v_mfma_f32_32x32x16_bf16 v[128:143], v[56:59], v[100:103], v[128:143]
    ds_read_b64_tr_b16 v[72:73], v8 offset:14336
    ds_read_b64_tr_b16 v[74:75], v8 offset:15360
    v_mfma_f32_32x32x16_bf16 v[144:159], v[60:63], v[100:103], v[144:159]
    ds_read_b64_tr_b16 v[76:77], v9 offset:14336
    ds_read_b64_tr_b16 v[78:79], v9 offset:15360
    s_waitcnt vmcnt(2) lgkmcnt(4)
    v_mfma_f32_32x32x16_bf16 v[128:143], v[64:67], v[104:107], v[128:143]
    v_mfma_f32_32x32x16_bf16 v[144:159], v[68:71], v[104:107], v[144:159]
    s_waitcnt vmcnt(1) lgkmcnt(0)
    v_mfma_f32_32x32x16_bf16 v[128:143], v[72:75], v[108:111], v[128:143]
    v_mfma_f32_32x32x16_bf16 v[144:159], v[76:79], v[108:111], v[144:159]
L_p2done:
    s_cbranch_vccz L_pwok
    s_mov_b32 s69, 0
L_pw:
    ds_read_b32 v3, v16
    s_add_u32 s69, s69, 1
    s_waitcnt lgkmcnt(0)
    v_cmp_ne_u32 vcc, s68, v3
    s_nop 3
    s_cbranch_vccz L_pwok
    s_cmp_lt_u32 s69, 2097152
    s_cbranch_scc1 L_pw
L_pwok:
    s_nop 9
    ds_write_b128 v14, v[128:131] offset:0
    ds_write_b128 v14, v[132:135] offset:32
    ds_write_b128 v14, v[136:139] offset:64
    ds_write_b128 v14, v[140:143] offset:96
    ds_write_b128 v14, v[144:147] offset:53520
    ds_write_b128 v14, v[148:151] offset:53552
    ds_write_b128 v14, v[152:155] offset:53584
    ds_write_b128 v14, v[156:159] offset:53616
    s_waitcnt vmcnt(0)
    v_lshlrev_b32 v36, 16, v44
    v_and_b32 v37, 0xffff0000, v44
    v_lshlrev_b32 v38, 16, v45
    v_and_b32 v39, 0xffff0000, v45
    v_lshlrev_b32 v40, 16, v46
    v_and_b32 v41, 0xffff0000, v46
    v_lshlrev_b32 v42, 16, v47
    v_and_b32 v43, 0xffff0000, v47
    s_waitcnt lgkmcnt(0)
    s_barrier
    ds_read_b128 v[48:51], v18 offset:12288
    ds_read_b128 v[52:55], v18 offset:12304
    ds_read_b128 v[64:67], v18 offset:24576
    ds_read_b128 v[68:71], v18 offset:24592
    ds_read_b128 v[72:75], v18 offset:36864
    ds_read_b128 v[76:79], v18 offset:36880
    ds_read_b128 v[56:59], v18 offset:0
    ds_read_b128 v[60:63], v18 offset:16
    s_waitcnt lgkmcnt(4)
    v_pk_add_f32 v[48:49], v[48:49], v[64:65]
    v_pk_add_f32 v[50:51], v[50:51], v[66:67]
    v_pk_add_f32 v[52:53], v[52:53], v[68:69]
    v_pk_add_f32 v[54:55], v[54:55], v[70:71]
    s_waitcnt lgkmcnt(2)
    v_pk_add_f32 v[48:49], v[48:49], v[72:73]
    v_pk_add_f32 v[50:51], v[50:51], v[74:75]
    v_pk_add_f32 v[52:53], v[52:53], v[76:77]
    v_pk_add_f32 v[54:55], v[54:55], v[78:79]
    v_pk_mul_f32 v[88:89], v[48:49], s[70:71]
    v_pk_mul_f32 v[90:91], v[50:51], s[70:71]
    v_pk_mul_f32 v[92:93], v[52:53], s[70:71]
    v_pk_mul_f32 v[94:95], v[54:55], s[70:71]
    v_exp_f32 v88, v88
    v_exp_f32 v89, v89
    v_exp_f32 v90, v90
    v_exp_f32 v91, v91
    v_exp_f32 v92, v92
    v_exp_f32 v93, v93
    v_exp_f32 v94, v94
    v_exp_f32 v95, v95
    s_waitcnt lgkmcnt(0)
    v_pk_mul_f32 v[56:57], v[56:57], v[48:49]
    v_pk_mul_f32 v[58:59], v[58:59], v[50:51]
    v_pk_mul_f32 v[60:61], v[60:61], v[52:53]
    v_pk_mul_f32 v[62:63], v[62:63], v[54:55]
    v_pk_add_f32 v[88:89], v[88:89], 1.0 op_sel_hi:[1,0]
    v_pk_add_f32 v[90:91], v[90:91], 1.0 op_sel_hi:[1,0]
    v_pk_add_f32 v[92:93], v[92:93], 1.0 op_sel_hi:[1,0]
    v_pk_add_f32 v[94:95], v[94:95], 1.0 op_sel_hi:[1,0]
    v_rcp_f32 v88, v88
    v_rcp_f32 v89, v89
    v_rcp_f32 v90, v90
    v_rcp_f32 v91, v91
    v_rcp_f32 v92, v92
    v_rcp_f32 v93, v93
    v_rcp_f32 v94, v94
    v_rcp_f32 v95, v95
    v_pk_fma_f32 v[88:89], v[88:89], v[56:57], v[36:37]
    v_pk_fma_f32 v[90:91], v[90:91], v[58:59], v[38:39]
    v_pk_fma_f32 v[92:93], v[92:93], v[60:61], v[40:41]
    v_pk_fma_f32 v[94:95], v[94:95], v[62:63], v[42:43]
    v_cvt_pk_bf16_f32 v44, v88, v89
    v_cvt_pk_bf16_f32 v45, v90, v91
    v_cvt_pk_bf16_f32 v46, v92, v93
    v_cvt_pk_bf16_f32 v47, v94, v95
    buffer_store_dwordx4 v[44:47], v13, s[24:27], 0 offen sc1
L_end:
    s_endpgm
L_ah:
    s_bitset0_b32 s0, s48
    s_ff1_i32_b32 s63, s0
    s_cmp_lg_u32 s48, s49
    s_cbranch_scc1 L_ah0
    s_sub_u32 s54, s54, 1024
    s_lshl_b32 s69, s53, 3
    s_sub_u32 s55, s55, s69
L_ah0:
    s_cmp_lt_u32 s48, 3
    s_cbranch_scc1 L_ah1
    buffer_load_dword v19, v18, s[84:87], s46 offen
L_ah1:
    s_lshl_b32 s69, s3, 3
    s_add_u32 s69, s69, s48
    s_cmp_lg_u32 s69, 1
    s_cbranch_scc1 L_aback
    v_readfirstlane_b32 s68, v24
    s_mov_b32 s69, 0
L_tagah:
    s_nop 2
    s_cmp_lg_u32 s68, 0
    s_cbranch_scc1 L_tagokah
    v_mov_b32 v1, 0
    global_load_dword v24, v1, s[28:29] sc1
    s_waitcnt vmcnt(0)
    v_readfirstlane_b32 s68, v24
    s_add_u32 s69, s69, 1
    s_cmp_lt_u32 s69, 262144
    s_cbranch_scc1 L_tagah
L_tagokah:
    v_mov_b32 v1, s68
    s_mov_b64 exec, 3
    buffer_store_dword v1, v23, s[80:83], 0 offen sc1
    s_mov_b64 exec, -1
    s_branch L_aback
L_codeend:
.fill (33024 - (L_codeend - recurrent_scan__sliding_local_dilated__swiglu_ffn__prompt_kernel)) / 4, 4, 0xbf810000
.section .rodata,"a"
.p2align 6
.amdhsa_kernel recurrent_scan__sliding_local_dilated__swiglu_ffn__prompt_kernel
  .amdhsa_next_free_vgpr 256
  .amdhsa_next_free_sgpr 102
  .amdhsa_accum_offset 160
  .amdhsa_group_segment_fixed_size 0
  .amdhsa_kernarg_size 80
  .amdhsa_user_sgpr_count 2
  .amdhsa_user_sgpr_kernarg_segment_ptr 1
  .amdhsa_system_sgpr_workgroup_id_x 1
.end_amdhsa_kernel
```
